```python
import torch

def _softmax(x, axis=-1):
    return torch.softmax(x, dim=axis)

def _gelu(x):
    return torch.nn.functional.gelu(x, approximate='tanh')

def _silu(x):
    return torch.nn.functional.silu(x)

def _sigmoid(x):
    return torch.sigmoid(x)

def _layernorm(x, axis=-1, eps=1e-05):
    m = x.mean(dim=axis, keepdim=True)
    v = x.var(dim=axis, keepdim=True, unbiased=False)
    return (x - m) / torch.sqrt(v + eps)

def _scatter_add(tgt, idx, src, axis=0):
    return tgt.clone().index_add_(axis, idx, src)

def _segment_sum(src, seg, n):
    out = torch.zeros((n,) + src.shape[1:], dtype=src.dtype)
    return out.index_add_(0, seg, src)

def _pad(x, pw):
    flat = tuple((v for pair in reversed(pw) for v in pair))
    return torch.nn.functional.pad(x, flat)
kernel_name = 'concat_heads__sliding_block__memory_aug_recurrent_mem_tr__prompt'

def setup_inputs():

    _w = lambda a: (lambda t: t.to(torch.bfloat16) if t.is_floating_point() else t)(torch.as_tensor(a))

    def _A_setup():
        B, S, D = (1, 2048, 1024)
        return {'x': _w((lambda *s: torch.randn(*s, dtype=torch.bfloat16) * 0.2)(B, S, D)), 'wqkv': _w((lambda *s: torch.randn(*s, dtype=torch.bfloat16) * 0.2)(D, 3 * D)), 'wo': _w((lambda *s: torch.randn(*s, dtype=torch.bfloat16) * 0.05)(D, D))}
    _A_in = _A_setup()

    def _B_setup():
        B, S, Dm = (1, 2048, 1024)
        H, Dh = (32, 128)
        M, seg = (8, 32)
        seg = min(seg, S)
        S = S // seg * seg
        return {'x': _w((lambda *s: torch.randn(*s, dtype=torch.bfloat16) * 0.05)(B, S, Dm)), 'mem0': _w((lambda *s: torch.randn(*s, dtype=torch.bfloat16) * 1.6)(B, M, Dm)), 'Wq': _w((lambda *s: torch.randn(*s, dtype=torch.bfloat16) * 0.8)(Dm, H, Dh) * Dm ** (-0.5)), 'Wk': _w((lambda *s: torch.randn(*s, dtype=torch.bfloat16) * 0.8)(Dm, H, Dh) * Dm ** (-0.5)), 'Wv': _w((lambda *s: torch.randn(*s, dtype=torch.bfloat16) * 1.6)(Dm, H, Dh) * Dm ** (-0.5)), 'Wo': _w((lambda *s: torch.randn(*s, dtype=torch.bfloat16) * 1.6)(H, Dh, Dm) * (H * Dh) ** (-0.5)), 'seg_len': seg}
    _B_in = _B_setup()
    return {'A_x': _A_in['x'], 'A_wqkv': _A_in['wqkv'], 'A_wo': _A_in['wo'], 'B_x': _B_in['x'], 'B_mem0': _B_in['mem0'], 'B_Wq': _B_in['Wq'], 'B_Wk': _B_in['Wk'], 'B_Wv': _B_in['Wv'], 'B_Wo': _B_in['Wo'], 'B_seg_len': _B_in['seg_len']}

def reference(A_x, A_wqkv, A_wo, B_x, B_mem0, B_Wq, B_Wk, B_Wv, B_Wo, B_seg_len):

    def _A_ref(x, wqkv, wo):
        B, S, D = x.shape
        H = 32
        Dh = D // H
        W = 256
        qkv = (lambda x, *d: x.permute(*d))((x @ wqkv).reshape(B, S, 3, H, Dh), 2, 0, 3, 1, 4)
        q, k, v = (qkv[0], qkv[1], qkv[2])
        scores = torch.einsum('bhqd,bhkd->bhqk', q, k) * Dh ** (-0.5)
        idx = torch.arange(S)
        mask = (idx[:, None] - idx[None, :] >= 0) & (idx[:, None] - idx[None, :] < W)
        scores = torch.where(mask[None, None], scores, -1000000000.0)
        p = _softmax(scores, axis=-1)
        o = torch.einsum('bhqk,bhkd->bhqd', p, v)
        return (lambda x, *d: x.permute(*d))(o, 0, 2, 1, 3).reshape(B, S, D) @ wo

    def _B_ref(x, mem0, Wq, Wk, Wv, Wo, seg_len):
        B, S, Dm = x.shape
        H, Dh = (Wq.shape[1], Wq.shape[2])
        M = mem0.shape[1]
        scale = Dh ** (-0.5)
        n_seg = S // seg_len
        L = M + seg_len
        idx = torch.arange(L)
        mask = (idx[:, None] < M) | (idx[:, None] >= idx[None, :])
        mem = mem0
        outs = []
        for s in range(n_seg):
            xs = x[:, s * seg_len:(s + 1) * seg_len, :].clone()
            h = torch.concatenate([mem, xs], axis=1)
            q = torch.einsum('btd,dhe->bhte', h, Wq)
            k = torch.einsum('btd,dhe->bhte', h, Wk)
            v = torch.einsum('btd,dhe->bhte', h, Wv)
            scores = torch.einsum('bhqe,bhke->bhqk', q, k) * scale
            scores = torch.where(mask[None, None], scores, -1000000000.0)
            p = _softmax(scores, axis=-1)
            o = torch.einsum('bhqk,bhke->bhqe', p, v)
            o = torch.einsum('bhte,hed->btd', o, Wo)
            mem = o[:, :M, :].clone()
            outs.append(o[:, M:, :])
        return torch.concatenate(outs, axis=1)
    a = _A_ref(A_x, A_wqkv, A_wo)
    b = _B_ref(B_x, B_mem0, B_Wq, B_Wk, B_Wv, B_Wo, B_seg_len)
    return torch.concatenate([a, b], axis=-1)
```

```asm
; @launch kernel=init_kernel grid=(1217,1,1) block=(256,1,1) lds=0
; @launch kernel=gemm1_kernel grid=(1024,1,1) block=(256,1,1) lds=65536
; @launch kernel=mega_kernel grid=(1152,1,1) block=(256,1,1) lds=73728
; @launch kernel=attna_kernel grid=(512,1,1) block=(256,1,1) lds=73728
; @launch kernel=attnb_kernel grid=(512,1,1) block=(256,1,1) lds=65536
; @launch kernel=gemm2_kernel grid=(256,1,1) block=(256,1,1) lds=65536
.amdgcn_target "amdgcn-amd-amdhsa--gfx950"
.text
.globl gemm1_kernel
.p2align 8
.type gemm1_kernel,@function
gemm1_kernel:
    s_cmp_ge_u32 s2, 512
    s_cbranch_scc1 gemm_p_2
    s_load_dwordx2 s[8:9], s[0:1], 24
    s_waitcnt lgkmcnt(0)
    s_mov_b32 s10, 0x400000
    s_mov_b32 s11, 0x00020000
    s_load_dwordx2 s[12:13], s[0:1], 48
    s_waitcnt lgkmcnt(0)
    s_mov_b32 s14, 0x800000
    s_mov_b32 s15, 0x00020000
    s_load_dwordx2 s[16:17], s[0:1], 96
    s_waitcnt lgkmcnt(0)
    s_add_u32 s16, s16, 0x1c00000
    s_addc_u32 s17, s17, 0
    s_mov_b32 s18, 0x1000000
    s_mov_b32 s19, 0x00020000
    s_mov_b32 s20, 2048
    s_mov_b32 s21, 8192
    s_mov_b32 s22, 8192
    s_mov_b32 s23, 16
    s_sub_u32 s3, s2, 0
    s_lshr_b32 s4, s3, 3
    s_and_b32 s24, s4, 15
    s_lshr_b32 s4, s4, 4
    s_lshl_b32 s4, s4, 3
    s_and_b32 s5, s3, 7
    s_add_u32 s25, s4, s5
    s_lshl_b32 s24, s24, 7
    s_lshl_b32 s25, s25, 7
    s_mov_b32 s29, 0
    s_mov_b32 s35, 0
    s_branch gemm_body_1
gemm_p_2:
    s_cmp_ge_u32 s2, 1024
    s_cbranch_scc1 gemm_p_3
    s_load_dwordx2 s[8:9], s[0:1], 24
    s_waitcnt lgkmcnt(0)
    s_mov_b32 s10, 0x400000
    s_mov_b32 s11, 0x00020000
    s_load_dwordx2 s[12:13], s[0:1], 56
    s_waitcnt lgkmcnt(0)
    s_mov_b32 s14, 0x800000
    s_mov_b32 s15, 0x00020000
    s_load_dwordx2 s[16:17], s[0:1], 96
    s_waitcnt lgkmcnt(0)
    s_add_u32 s16, s16, 0x2c00000
    s_addc_u32 s17, s17, 0
    s_mov_b32 s18, 0x1000000
    s_mov_b32 s19, 0x00020000
    s_mov_b32 s20, 2048
    s_mov_b32 s21, 8192
    s_mov_b32 s22, 8192
    s_mov_b32 s23, 16
    s_sub_u32 s3, s2, 512
    s_lshr_b32 s4, s3, 3
    s_and_b32 s24, s4, 15
    s_lshr_b32 s4, s4, 4
    s_lshl_b32 s4, s4, 3
    s_and_b32 s5, s3, 7
    s_add_u32 s25, s4, s5
    s_lshl_b32 s24, s24, 7
    s_lshl_b32 s25, s25, 7
    s_mov_b32 s29, 0
    s_mov_b32 s35, 0
    s_branch gemm_body_1
gemm_p_3:
    s_endpgm
gemm_body_1:
    v_and_b32 v1, 63, v0
    v_lshrrev_b32 v2, 6, v0
    s_nop 0
    v_readfirstlane_b32 s26, v2
    s_nop 3
    s_lshr_b32 s30, s26, 1
    s_and_b32 s31, s26, 1

    v_lshrrev_b32 v2, 3, v1
    v_lshrrev_b32 v3, 4, v1
    v_and_b32 v4, 7, v1
    s_lshl_b32 s4, s26, 5
    s_add_u32 s4, s4, s24

    v_add_u32 v5, 0, v2
    v_add_u32 v5, s4, v5
    v_mul_lo_u32 v6, v5, s20
    v_add_u32 v7, 0, v3
    v_xor_b32 v7, v7, v4
    v_lshlrev_b32 v7, 4, v7
    v_add_u32 v10, v6, v7

    v_add_u32 v5, 8, v2
    v_add_u32 v5, s4, v5
    v_mul_lo_u32 v6, v5, s20
    v_add_u32 v7, 4, v3
    v_xor_b32 v7, v7, v4
    v_lshlrev_b32 v7, 4, v7
    v_add_u32 v11, v6, v7

    v_add_u32 v5, 16, v2
    v_add_u32 v5, s4, v5
    v_mul_lo_u32 v6, v5, s20
    v_add_u32 v7, 0, v3
    v_xor_b32 v7, v7, v4
    v_lshlrev_b32 v7, 4, v7
    v_add_u32 v12, v6, v7

    v_add_u32 v5, 24, v2
    v_add_u32 v5, s4, v5
    v_mul_lo_u32 v6, v5, s20
    v_add_u32 v7, 4, v3
    v_xor_b32 v7, v7, v4
    v_lshlrev_b32 v7, 4, v7
    v_add_u32 v13, v6, v7

    v_bfe_u32 v5, v1, 2, 2
    v_xor_b32 v5, v5, v3
    v_lshlrev_b32 v5, 6, v5
    v_and_b32 v6, 3, v1
    v_lshlrev_b32 v6, 4, v6
    v_add_u32 v5, v5, v6
    s_lshl_b32 s5, s25, 1
    v_add_u32 v5, s5, v5
    s_lshl_b32 s4, s26, 4

    v_add_u32 v6, 0, v3
    v_add_u32 v6, s4, v6
    v_mul_lo_u32 v6, v6, s21
    v_add_u32 v14, v6, v5

    v_add_u32 v6, 4, v3
    v_add_u32 v6, s4, v6
    v_mul_lo_u32 v6, v6, s21
    v_add_u32 v15, v6, v5

    v_add_u32 v6, 8, v3
    v_add_u32 v6, s4, v6
    v_mul_lo_u32 v6, v6, s21
    v_add_u32 v16, v6, v5

    v_add_u32 v6, 12, v3
    v_add_u32 v6, s4, v6
    v_mul_lo_u32 v6, v6, s21
    v_add_u32 v17, v6, v5

    v_and_b32 v5, 31, v1
    v_lshrrev_b32 v6, 5, v1
    s_lshl_b32 s4, s30, 6
    v_add_u32 v7, s4, v5
    v_lshlrev_b32 v7, 7, v7
    v_bfe_u32 v8, v5, 1, 3
    v_xor_b32 v8, v8, v6
    v_lshlrev_b32 v8, 4, v8
    v_add_u32 v20, v7, v8
    v_xor_b32 v21, 32, v20
    v_xor_b32 v22, 64, v20
    v_xor_b32 v23, 96, v20
    v_bfe_u32 v5, v1, 2, 2
    v_lshlrev_b32 v7, 11, v6
    v_lshlrev_b32 v8, 8, v5
    v_add_u32 v7, v7, v8
    v_bfe_u32 v8, v1, 4, 1
    v_lshlrev_b32 v8, 5, v8
    v_add_u32 v7, v7, v8
    v_and_b32 v8, 3, v1
    v_lshlrev_b32 v8, 3, v8
    v_add_u32 v7, v7, v8
    v_add_u32 v7, 0x4000, v7
    s_lshl_b32 s4, s31, 1

    s_add_u32 s5, s4, 0
    v_xor_b32 v8, s5, v5
    v_lshlrev_b32 v8, 6, v8
    v_add_u32 v24, v7, v8

    s_add_u32 s5, s4, 1
    v_xor_b32 v8, s5, v5
    v_lshlrev_b32 v8, 6, v8
    v_add_u32 v25, v7, v8

    v_mov_b32 v64, 0
    v_mov_b32 v65, 0
    v_mov_b32 v66, 0
    v_mov_b32 v67, 0
    v_mov_b32 v68, 0
    v_mov_b32 v69, 0
    v_mov_b32 v70, 0
    v_mov_b32 v71, 0
    v_mov_b32 v72, 0
    v_mov_b32 v73, 0
    v_mov_b32 v74, 0
    v_mov_b32 v75, 0
    v_mov_b32 v76, 0
    v_mov_b32 v77, 0
    v_mov_b32 v78, 0
    v_mov_b32 v79, 0
    v_mov_b32 v80, 0
    v_mov_b32 v81, 0
    v_mov_b32 v82, 0
    v_mov_b32 v83, 0
    v_mov_b32 v84, 0
    v_mov_b32 v85, 0
    v_mov_b32 v86, 0
    v_mov_b32 v87, 0
    v_mov_b32 v88, 0
    v_mov_b32 v89, 0
    v_mov_b32 v90, 0
    v_mov_b32 v91, 0
    v_mov_b32 v92, 0
    v_mov_b32 v93, 0
    v_mov_b32 v94, 0
    v_mov_b32 v95, 0
    v_mov_b32 v96, 0
    v_mov_b32 v97, 0
    v_mov_b32 v98, 0
    v_mov_b32 v99, 0
    v_mov_b32 v100, 0
    v_mov_b32 v101, 0
    v_mov_b32 v102, 0
    v_mov_b32 v103, 0
    v_mov_b32 v104, 0
    v_mov_b32 v105, 0
    v_mov_b32 v106, 0
    v_mov_b32 v107, 0
    v_mov_b32 v108, 0
    v_mov_b32 v109, 0
    v_mov_b32 v110, 0
    v_mov_b32 v111, 0
    v_mov_b32 v112, 0
    v_mov_b32 v113, 0
    v_mov_b32 v114, 0
    v_mov_b32 v115, 0
    v_mov_b32 v116, 0
    v_mov_b32 v117, 0
    v_mov_b32 v118, 0
    v_mov_b32 v119, 0
    v_mov_b32 v120, 0
    v_mov_b32 v121, 0
    v_mov_b32 v122, 0
    v_mov_b32 v123, 0
    v_mov_b32 v124, 0
    v_mov_b32 v125, 0
    v_mov_b32 v126, 0
    v_mov_b32 v127, 0
    s_mov_b32 s27, 0
    s_mov_b32 s28, 0
    s_lshl_b32 s32, s21, 6
    s_lshl_b32 s33, s26, 12
    s_add_u32 m0, s33, 0
    s_nop 0
    buffer_load_dwordx4 v10, s[8:11], s27 offen lds
    s_add_u32 m0, s33, 1024
    s_nop 0
    buffer_load_dwordx4 v11, s[8:11], s27 offen lds
    s_add_u32 m0, s33, 2048
    s_nop 0
    buffer_load_dwordx4 v12, s[8:11], s27 offen lds
    s_add_u32 m0, s33, 3072
    s_nop 0
    buffer_load_dwordx4 v13, s[8:11], s27 offen lds
    s_add_u32 m0, s33, 16384
    s_nop 0
    buffer_load_dwordx4 v14, s[12:15], s28 offen lds
    s_add_u32 m0, s33, 17408
    s_nop 0
    buffer_load_dwordx4 v15, s[12:15], s28 offen lds
    s_add_u32 m0, s33, 18432
    s_nop 0
    buffer_load_dwordx4 v16, s[12:15], s28 offen lds
    s_add_u32 m0, s33, 19456
    s_nop 0
    buffer_load_dwordx4 v17, s[12:15], s28 offen lds
    s_add_u32 s27, s27, 128
    s_add_u32 s28, s28, s32
    s_mov_b32 s34, 0
gemm_loop_4:
    s_add_u32 m0, s33, 32768
    s_nop 0
    buffer_load_dwordx4 v10, s[8:11], s27 offen lds
    s_add_u32 m0, s33, 33792
    s_nop 0
    buffer_load_dwordx4 v11, s[8:11], s27 offen lds
    s_add_u32 m0, s33, 34816
    s_nop 0
    buffer_load_dwordx4 v12, s[8:11], s27 offen lds
    s_add_u32 m0, s33, 35840
    s_nop 0
    buffer_load_dwordx4 v13, s[8:11], s27 offen lds
    s_add_u32 m0, s33, 49152
    s_nop 0
    buffer_load_dwordx4 v14, s[12:15], s28 offen lds
    s_add_u32 m0, s33, 50176
    s_nop 0
    buffer_load_dwordx4 v15, s[12:15], s28 offen lds
    s_add_u32 m0, s33, 51200
    s_nop 0
    buffer_load_dwordx4 v16, s[12:15], s28 offen lds
    s_add_u32 m0, s33, 52224
    s_nop 0
    buffer_load_dwordx4 v17, s[12:15], s28 offen lds
    s_add_u32 s27, s27, 128
    s_add_u32 s28, s28, s32
    s_waitcnt vmcnt(8)
    s_barrier
    ds_read_b128 v[32:35], v20 offset:0
    ds_read_b128 v[36:39], v20 offset:4096
    ds_read_b64_tr_b16 v[40:41], v24 offset:0
    ds_read_b64_tr_b16 v[42:43], v24 offset:1024
    ds_read_b64_tr_b16 v[44:45], v25 offset:0
    ds_read_b64_tr_b16 v[46:47], v25 offset:1024
    ds_read_b128 v[48:51], v21 offset:0
    ds_read_b128 v[52:55], v21 offset:4096
    ds_read_b64_tr_b16 v[56:57], v24 offset:4096
    ds_read_b64_tr_b16 v[58:59], v24 offset:5120
    ds_read_b64_tr_b16 v[60:61], v25 offset:4096
    ds_read_b64_tr_b16 v[62:63], v25 offset:5120
    s_waitcnt lgkmcnt(6)
    v_mfma_f32_32x32x16_bf16 v[64:79], v[40:43], v[32:35], v[64:79]
    v_mfma_f32_32x32x16_bf16 v[80:95], v[40:43], v[36:39], v[80:95]
    v_mfma_f32_32x32x16_bf16 v[96:111], v[44:47], v[32:35], v[96:111]
    v_mfma_f32_32x32x16_bf16 v[112:127], v[44:47], v[36:39], v[112:127]
    ds_read_b128 v[32:35], v22 offset:0
    ds_read_b128 v[36:39], v22 offset:4096
    ds_read_b64_tr_b16 v[40:41], v24 offset:8192
    ds_read_b64_tr_b16 v[42:43], v24 offset:9216
    ds_read_b64_tr_b16 v[44:45], v25 offset:8192
    ds_read_b64_tr_b16 v[46:47], v25 offset:9216
    s_waitcnt lgkmcnt(6)
    v_mfma_f32_32x32x16_bf16 v[64:79], v[56:59], v[48:51], v[64:79]
    v_mfma_f32_32x32x16_bf16 v[80:95], v[56:59], v[52:55], v[80:95]
    v_mfma_f32_32x32x16_bf16 v[96:111], v[60:63], v[48:51], v[96:111]
    v_mfma_f32_32x32x16_bf16 v[112:127], v[60:63], v[52:55], v[112:127]
    ds_read_b128 v[48:51], v23 offset:0
    ds_read_b128 v[52:55], v23 offset:4096
    ds_read_b64_tr_b16 v[56:57], v24 offset:12288
    ds_read_b64_tr_b16 v[58:59], v24 offset:13312
    ds_read_b64_tr_b16 v[60:61], v25 offset:12288
    ds_read_b64_tr_b16 v[62:63], v25 offset:13312
    s_waitcnt lgkmcnt(6)
    v_mfma_f32_32x32x16_bf16 v[64:79], v[40:43], v[32:35], v[64:79]
    v_mfma_f32_32x32x16_bf16 v[80:95], v[40:43], v[36:39], v[80:95]
    v_mfma_f32_32x32x16_bf16 v[96:111], v[44:47], v[32:35], v[96:111]
    v_mfma_f32_32x32x16_bf16 v[112:127], v[44:47], v[36:39], v[112:127]
    s_waitcnt lgkmcnt(0)
    v_mfma_f32_32x32x16_bf16 v[64:79], v[56:59], v[48:51], v[64:79]
    v_mfma_f32_32x32x16_bf16 v[80:95], v[56:59], v[52:55], v[80:95]
    v_mfma_f32_32x32x16_bf16 v[96:111], v[60:63], v[48:51], v[96:111]
    v_mfma_f32_32x32x16_bf16 v[112:127], v[60:63], v[52:55], v[112:127]
    s_barrier
    s_add_u32 s34, s34, 2
    s_cmp_ge_u32 s34, s23
    s_cbranch_scc1 gemm_last_5
    s_add_u32 m0, s33, 0
    s_nop 0
    buffer_load_dwordx4 v10, s[8:11], s27 offen lds
    s_add_u32 m0, s33, 1024
    s_nop 0
    buffer_load_dwordx4 v11, s[8:11], s27 offen lds
    s_add_u32 m0, s33, 2048
    s_nop 0
    buffer_load_dwordx4 v12, s[8:11], s27 offen lds
    s_add_u32 m0, s33, 3072
    s_nop 0
    buffer_load_dwordx4 v13, s[8:11], s27 offen lds
    s_add_u32 m0, s33, 16384
    s_nop 0
    buffer_load_dwordx4 v14, s[12:15], s28 offen lds
    s_add_u32 m0, s33, 17408
    s_nop 0
    buffer_load_dwordx4 v15, s[12:15], s28 offen lds
    s_add_u32 m0, s33, 18432
    s_nop 0
    buffer_load_dwordx4 v16, s[12:15], s28 offen lds
    s_add_u32 m0, s33, 19456
    s_nop 0
    buffer_load_dwordx4 v17, s[12:15], s28 offen lds
    s_add_u32 s27, s27, 128
    s_add_u32 s28, s28, s32
    s_waitcnt vmcnt(8)
    s_branch gemm_join_6
gemm_last_5:
    s_waitcnt vmcnt(0)
gemm_join_6:
    s_barrier
    ds_read_b128 v[32:35], v20 offset:32768
    ds_read_b128 v[36:39], v20 offset:36864
    ds_read_b64_tr_b16 v[40:41], v24 offset:32768
    ds_read_b64_tr_b16 v[42:43], v24 offset:33792
    ds_read_b64_tr_b16 v[44:45], v25 offset:32768
    ds_read_b64_tr_b16 v[46:47], v25 offset:33792
    ds_read_b128 v[48:51], v21 offset:32768
    ds_read_b128 v[52:55], v21 offset:36864
    ds_read_b64_tr_b16 v[56:57], v24 offset:36864
    ds_read_b64_tr_b16 v[58:59], v24 offset:37888
    ds_read_b64_tr_b16 v[60:61], v25 offset:36864
    ds_read_b64_tr_b16 v[62:63], v25 offset:37888
    s_waitcnt lgkmcnt(6)
    v_mfma_f32_32x32x16_bf16 v[64:79], v[40:43], v[32:35], v[64:79]
    v_mfma_f32_32x32x16_bf16 v[80:95], v[40:43], v[36:39], v[80:95]
    v_mfma_f32_32x32x16_bf16 v[96:111], v[44:47], v[32:35], v[96:111]
    v_mfma_f32_32x32x16_bf16 v[112:127], v[44:47], v[36:39], v[112:127]
    ds_read_b128 v[32:35], v22 offset:32768
    ds_read_b128 v[36:39], v22 offset:36864
    ds_read_b64_tr_b16 v[40:41], v24 offset:40960
    ds_read_b64_tr_b16 v[42:43], v24 offset:41984
    ds_read_b64_tr_b16 v[44:45], v25 offset:40960
    ds_read_b64_tr_b16 v[46:47], v25 offset:41984
    s_waitcnt lgkmcnt(6)
    v_mfma_f32_32x32x16_bf16 v[64:79], v[56:59], v[48:51], v[64:79]
    v_mfma_f32_32x32x16_bf16 v[80:95], v[56:59], v[52:55], v[80:95]
    v_mfma_f32_32x32x16_bf16 v[96:111], v[60:63], v[48:51], v[96:111]
    v_mfma_f32_32x32x16_bf16 v[112:127], v[60:63], v[52:55], v[112:127]
    ds_read_b128 v[48:51], v23 offset:32768
    ds_read_b128 v[52:55], v23 offset:36864
    ds_read_b64_tr_b16 v[56:57], v24 offset:45056
    ds_read_b64_tr_b16 v[58:59], v24 offset:46080
    ds_read_b64_tr_b16 v[60:61], v25 offset:45056
    ds_read_b64_tr_b16 v[62:63], v25 offset:46080
    s_waitcnt lgkmcnt(6)
    v_mfma_f32_32x32x16_bf16 v[64:79], v[40:43], v[32:35], v[64:79]
    v_mfma_f32_32x32x16_bf16 v[80:95], v[40:43], v[36:39], v[80:95]
    v_mfma_f32_32x32x16_bf16 v[96:111], v[44:47], v[32:35], v[96:111]
    v_mfma_f32_32x32x16_bf16 v[112:127], v[44:47], v[36:39], v[112:127]
    s_waitcnt lgkmcnt(0)
    v_mfma_f32_32x32x16_bf16 v[64:79], v[56:59], v[48:51], v[64:79]
    v_mfma_f32_32x32x16_bf16 v[80:95], v[56:59], v[52:55], v[80:95]
    v_mfma_f32_32x32x16_bf16 v[96:111], v[60:63], v[48:51], v[96:111]
    v_mfma_f32_32x32x16_bf16 v[112:127], v[60:63], v[52:55], v[112:127]
    s_barrier
    s_cmp_lt_u32 s34, s23
    s_cbranch_scc1 gemm_loop_4
    s_nop 15
    v_and_b32 v2, 31, v1
    s_lshl_b32 s4, s30, 6
    s_add_u32 s4, s4, s24
    v_add_u32 v2, s4, v2
    v_mul_lo_u32 v2, v2, s22
    v_lshrrev_b32 v3, 5, v1
    v_lshlrev_b32 v3, 3, v3
    s_lshl_b32 s4, s31, 6
    s_add_u32 s4, s4, s25
    s_add_u32 s4, s4, s29
    s_lshl_b32 s4, s4, 1
    v_add_u32 v3, s4, v3
    v_add_u32 v2, v2, v3
    s_lshl_b32 s5, s22, 5
    v_add_u32 v3, s5, v2

    v_cvt_pk_bf16_f32 v32, v64, v65
    v_cvt_pk_bf16_f32 v33, v66, v67
    buffer_store_dwordx2 v[32:33], v2, s[16:19], 0 offen offset:0
    v_cvt_pk_bf16_f32 v34, v68, v69
    v_cvt_pk_bf16_f32 v35, v70, v71
    buffer_store_dwordx2 v[34:35], v2, s[16:19], 0 offen offset:16
    v_cvt_pk_bf16_f32 v36, v72, v73
    v_cvt_pk_bf16_f32 v37, v74, v75
    buffer_store_dwordx2 v[36:37], v2, s[16:19], 0 offen offset:32
    v_cvt_pk_bf16_f32 v38, v76, v77
    v_cvt_pk_bf16_f32 v39, v78, v79
    buffer_store_dwordx2 v[38:39], v2, s[16:19], 0 offen offset:48
    v_cvt_pk_bf16_f32 v40, v80, v81
    v_cvt_pk_bf16_f32 v41, v82, v83
    buffer_store_dwordx2 v[40:41], v3, s[16:19], 0 offen offset:0
    v_cvt_pk_bf16_f32 v42, v84, v85
    v_cvt_pk_bf16_f32 v43, v86, v87
    buffer_store_dwordx2 v[42:43], v3, s[16:19], 0 offen offset:16
    v_cvt_pk_bf16_f32 v44, v88, v89
    v_cvt_pk_bf16_f32 v45, v90, v91
    buffer_store_dwordx2 v[44:45], v3, s[16:19], 0 offen offset:32
    v_cvt_pk_bf16_f32 v46, v92, v93
    v_cvt_pk_bf16_f32 v47, v94, v95
    buffer_store_dwordx2 v[46:47], v3, s[16:19], 0 offen offset:48
    v_cvt_pk_bf16_f32 v48, v96, v97
    v_cvt_pk_bf16_f32 v49, v98, v99
    buffer_store_dwordx2 v[48:49], v2, s[16:19], 0 offen offset:64
    v_cvt_pk_bf16_f32 v50, v100, v101
    v_cvt_pk_bf16_f32 v51, v102, v103
    buffer_store_dwordx2 v[50:51], v2, s[16:19], 0 offen offset:80
    v_cvt_pk_bf16_f32 v52, v104, v105
    v_cvt_pk_bf16_f32 v53, v106, v107
    buffer_store_dwordx2 v[52:53], v2, s[16:19], 0 offen offset:96
    v_cvt_pk_bf16_f32 v54, v108, v109
    v_cvt_pk_bf16_f32 v55, v110, v111
    buffer_store_dwordx2 v[54:55], v2, s[16:19], 0 offen offset:112
    v_cvt_pk_bf16_f32 v56, v112, v113
    v_cvt_pk_bf16_f32 v57, v114, v115
    buffer_store_dwordx2 v[56:57], v3, s[16:19], 0 offen offset:64
    v_cvt_pk_bf16_f32 v58, v116, v117
    v_cvt_pk_bf16_f32 v59, v118, v119
    buffer_store_dwordx2 v[58:59], v3, s[16:19], 0 offen offset:80
    v_cvt_pk_bf16_f32 v60, v120, v121
    v_cvt_pk_bf16_f32 v61, v122, v123
    buffer_store_dwordx2 v[60:61], v3, s[16:19], 0 offen offset:96
    v_cvt_pk_bf16_f32 v62, v124, v125
    v_cvt_pk_bf16_f32 v63, v126, v127
    buffer_store_dwordx2 v[62:63], v3, s[16:19], 0 offen offset:112
    s_cmp_eq_u32 s35, 0
    s_cbranch_scc1 gemm_nosig_7
    s_load_dwordx2 s[40:41], s[0:1], 96
    s_waitcnt lgkmcnt(0)
    s_mov_b32 s42, 0x10000000
    s_mov_b32 s43, 0x00020000
    s_waitcnt vmcnt(0)
    s_barrier
    v_cmp_eq_u32 vcc, 0, v0
    s_and_saveexec_b64 s[44:45], vcc
    s_cbranch_execz sc_8
    buffer_wbl2 sc1
    s_waitcnt vmcnt(0)
    v_mov_b32 v2, 0
    v_mov_b32 v3, 1
    buffer_atomic_add v3, v2, s[40:43], s35 offen

sc_8:
    s_mov_b64 exec, s[44:45]
gemm_nosig_7:
    s_endpgm
.globl gemm2_kernel
.p2align 8
.type gemm2_kernel,@function
gemm2_kernel:
    s_cmp_ge_u32 s2, 128
    s_cbranch_scc1 gemm_p_10
    s_load_dwordx2 s[8:9], s[0:1], 96
    s_waitcnt lgkmcnt(0)
    s_add_u32 s8, s8, 0x3c00000
    s_addc_u32 s9, s9, 0
    s_mov_b32 s10, 0x400000
    s_mov_b32 s11, 0x00020000
    s_load_dwordx2 s[12:13], s[0:1], 16
    s_waitcnt lgkmcnt(0)
    s_mov_b32 s14, 0x200000
    s_mov_b32 s15, 0x00020000
    s_load_dwordx2 s[16:17], s[0:1], 80
    s_waitcnt lgkmcnt(0)
    s_mov_b32 s18, 0x800000
    s_mov_b32 s19, 0x00020000
    s_mov_b32 s20, 2048
    s_mov_b32 s21, 2048
    s_mov_b32 s22, 4096
    s_mov_b32 s23, 16
    s_sub_u32 s3, s2, 0
    s_lshr_b32 s4, s3, 3
    s_and_b32 s24, s4, 15
    s_lshr_b32 s4, s4, 4
    s_lshl_b32 s4, s4, 3
    s_and_b32 s5, s3, 7
    s_add_u32 s25, s4, s5
    s_lshl_b32 s24, s24, 7
    s_lshl_b32 s25, s25, 7
    s_mov_b32 s29, 0
    s_mov_b32 s35, 0
    s_branch gemm_body_9
gemm_p_10:
    s_cmp_ge_u32 s2, 256
    s_cbranch_scc1 gemm_p_11
    s_load_dwordx2 s[8:9], s[0:1], 96
    s_waitcnt lgkmcnt(0)
    s_add_u32 s8, s8, 0x4000000
    s_addc_u32 s9, s9, 0
    s_mov_b32 s10, 0x1000000
    s_mov_b32 s11, 0x00020000
    s_load_dwordx2 s[12:13], s[0:1], 64
    s_waitcnt lgkmcnt(0)
    s_mov_b32 s14, 0x800000
    s_mov_b32 s15, 0x00020000
    s_load_dwordx2 s[16:17], s[0:1], 80
    s_waitcnt lgkmcnt(0)
    s_mov_b32 s18, 0x800000
    s_mov_b32 s19, 0x00020000
    s_mov_b32 s20, 8192
    s_mov_b32 s21, 2048
    s_mov_b32 s22, 4096
    s_mov_b32 s23, 64
    s_sub_u32 s3, s2, 128
    s_lshr_b32 s4, s3, 3
    s_and_b32 s24, s4, 15
    s_lshr_b32 s4, s4, 4
    s_lshl_b32 s4, s4, 3
    s_and_b32 s5, s3, 7
    s_add_u32 s25, s4, s5
    s_lshl_b32 s24, s24, 7
    s_lshl_b32 s25, s25, 7
    s_mov_b32 s29, 1024
    s_mov_b32 s35, 0
    s_branch gemm_body_9
gemm_p_11:
    s_endpgm
gemm_body_9:
    v_and_b32 v1, 63, v0
    v_lshrrev_b32 v2, 6, v0
    s_nop 0
    v_readfirstlane_b32 s26, v2
    s_nop 3
    s_lshr_b32 s30, s26, 1
    s_and_b32 s31, s26, 1

    v_lshrrev_b32 v2, 3, v1
    v_lshrrev_b32 v3, 4, v1
    v_and_b32 v4, 7, v1
    s_lshl_b32 s4, s26, 5
    s_add_u32 s4, s4, s24

    v_add_u32 v5, 0, v2
    v_add_u32 v5, s4, v5
    v_mul_lo_u32 v6, v5, s20
    v_add_u32 v7, 0, v3
    v_xor_b32 v7, v7, v4
    v_lshlrev_b32 v7, 4, v7
    v_add_u32 v10, v6, v7

    v_add_u32 v5, 8, v2
    v_add_u32 v5, s4, v5
    v_mul_lo_u32 v6, v5, s20
    v_add_u32 v7, 4, v3
    v_xor_b32 v7, v7, v4
    v_lshlrev_b32 v7, 4, v7
    v_add_u32 v11, v6, v7

    v_add_u32 v5, 16, v2
    v_add_u32 v5, s4, v5
    v_mul_lo_u32 v6, v5, s20
    v_add_u32 v7, 0, v3
    v_xor_b32 v7, v7, v4
    v_lshlrev_b32 v7, 4, v7
    v_add_u32 v12, v6, v7

    v_add_u32 v5, 24, v2
    v_add_u32 v5, s4, v5
    v_mul_lo_u32 v6, v5, s20
    v_add_u32 v7, 4, v3
    v_xor_b32 v7, v7, v4
    v_lshlrev_b32 v7, 4, v7
    v_add_u32 v13, v6, v7

    v_bfe_u32 v5, v1, 2, 2
    v_xor_b32 v5, v5, v3
    v_lshlrev_b32 v5, 6, v5
    v_and_b32 v6, 3, v1
    v_lshlrev_b32 v6, 4, v6
    v_add_u32 v5, v5, v6
    s_lshl_b32 s5, s25, 1
    v_add_u32 v5, s5, v5
    s_lshl_b32 s4, s26, 4

    v_add_u32 v6, 0, v3
    v_add_u32 v6, s4, v6
    v_mul_lo_u32 v6, v6, s21
    v_add_u32 v14, v6, v5

    v_add_u32 v6, 4, v3
    v_add_u32 v6, s4, v6
    v_mul_lo_u32 v6, v6, s21
    v_add_u32 v15, v6, v5

    v_add_u32 v6, 8, v3
    v_add_u32 v6, s4, v6
    v_mul_lo_u32 v6, v6, s21
    v_add_u32 v16, v6, v5

    v_add_u32 v6, 12, v3
    v_add_u32 v6, s4, v6
    v_mul_lo_u32 v6, v6, s21
    v_add_u32 v17, v6, v5

    v_and_b32 v5, 31, v1
    v_lshrrev_b32 v6, 5, v1
    s_lshl_b32 s4, s30, 6
    v_add_u32 v7, s4, v5
    v_lshlrev_b32 v7, 7, v7
    v_bfe_u32 v8, v5, 1, 3
    v_xor_b32 v8, v8, v6
    v_lshlrev_b32 v8, 4, v8
    v_add_u32 v20, v7, v8
    v_xor_b32 v21, 32, v20
    v_xor_b32 v22, 64, v20
    v_xor_b32 v23, 96, v20
    v_bfe_u32 v5, v1, 2, 2
    v_lshlrev_b32 v7, 11, v6
    v_lshlrev_b32 v8, 8, v5
    v_add_u32 v7, v7, v8
    v_bfe_u32 v8, v1, 4, 1
    v_lshlrev_b32 v8, 5, v8
    v_add_u32 v7, v7, v8
    v_and_b32 v8, 3, v1
    v_lshlrev_b32 v8, 3, v8
    v_add_u32 v7, v7, v8
    v_add_u32 v7, 0x4000, v7
    s_lshl_b32 s4, s31, 1

    s_add_u32 s5, s4, 0
    v_xor_b32 v8, s5, v5
    v_lshlrev_b32 v8, 6, v8
    v_add_u32 v24, v7, v8

    s_add_u32 s5, s4, 1
    v_xor_b32 v8, s5, v5
    v_lshlrev_b32 v8, 6, v8
    v_add_u32 v25, v7, v8

    v_mov_b32 v64, 0
    v_mov_b32 v65, 0
    v_mov_b32 v66, 0
    v_mov_b32 v67, 0
    v_mov_b32 v68, 0
    v_mov_b32 v69, 0
    v_mov_b32 v70, 0
    v_mov_b32 v71, 0
    v_mov_b32 v72, 0
    v_mov_b32 v73, 0
    v_mov_b32 v74, 0
    v_mov_b32 v75, 0
    v_mov_b32 v76, 0
    v_mov_b32 v77, 0
    v_mov_b32 v78, 0
    v_mov_b32 v79, 0
    v_mov_b32 v80, 0
    v_mov_b32 v81, 0
    v_mov_b32 v82, 0
    v_mov_b32 v83, 0
    v_mov_b32 v84, 0
    v_mov_b32 v85, 0
    v_mov_b32 v86, 0
    v_mov_b32 v87, 0
    v_mov_b32 v88, 0
    v_mov_b32 v89, 0
    v_mov_b32 v90, 0
    v_mov_b32 v91, 0
    v_mov_b32 v92, 0
    v_mov_b32 v93, 0
    v_mov_b32 v94, 0
    v_mov_b32 v95, 0
    v_mov_b32 v96, 0
    v_mov_b32 v97, 0
    v_mov_b32 v98, 0
    v_mov_b32 v99, 0
    v_mov_b32 v100, 0
    v_mov_b32 v101, 0
    v_mov_b32 v102, 0
    v_mov_b32 v103, 0
    v_mov_b32 v104, 0
    v_mov_b32 v105, 0
    v_mov_b32 v106, 0
    v_mov_b32 v107, 0
    v_mov_b32 v108, 0
    v_mov_b32 v109, 0
    v_mov_b32 v110, 0
    v_mov_b32 v111, 0
    v_mov_b32 v112, 0
    v_mov_b32 v113, 0
    v_mov_b32 v114, 0
    v_mov_b32 v115, 0
    v_mov_b32 v116, 0
    v_mov_b32 v117, 0
    v_mov_b32 v118, 0
    v_mov_b32 v119, 0
    v_mov_b32 v120, 0
    v_mov_b32 v121, 0
    v_mov_b32 v122, 0
    v_mov_b32 v123, 0
    v_mov_b32 v124, 0
    v_mov_b32 v125, 0
    v_mov_b32 v126, 0
    v_mov_b32 v127, 0
    s_mov_b32 s27, 0
    s_mov_b32 s28, 0
    s_lshl_b32 s32, s21, 6
    s_lshl_b32 s33, s26, 12
    s_add_u32 m0, s33, 0
    s_nop 0
    buffer_load_dwordx4 v10, s[8:11], s27 offen lds
    s_add_u32 m0, s33, 1024
    s_nop 0
    buffer_load_dwordx4 v11, s[8:11], s27 offen lds
    s_add_u32 m0, s33, 2048
    s_nop 0
    buffer_load_dwordx4 v12, s[8:11], s27 offen lds
    s_add_u32 m0, s33, 3072
    s_nop 0
    buffer_load_dwordx4 v13, s[8:11], s27 offen lds
    s_add_u32 m0, s33, 16384
    s_nop 0
    buffer_load_dwordx4 v14, s[12:15], s28 offen lds
    s_add_u32 m0, s33, 17408
    s_nop 0
    buffer_load_dwordx4 v15, s[12:15], s28 offen lds
    s_add_u32 m0, s33, 18432
    s_nop 0
    buffer_load_dwordx4 v16, s[12:15], s28 offen lds
    s_add_u32 m0, s33, 19456
    s_nop 0
    buffer_load_dwordx4 v17, s[12:15], s28 offen lds
    s_add_u32 s27, s27, 128
    s_add_u32 s28, s28, s32
    s_mov_b32 s34, 0
gemm_loop_12:
    s_add_u32 m0, s33, 32768
    s_nop 0
    buffer_load_dwordx4 v10, s[8:11], s27 offen lds
    s_add_u32 m0, s33, 33792
    s_nop 0
    buffer_load_dwordx4 v11, s[8:11], s27 offen lds
    s_add_u32 m0, s33, 34816
    s_nop 0
    buffer_load_dwordx4 v12, s[8:11], s27 offen lds
    s_add_u32 m0, s33, 35840
    s_nop 0
    buffer_load_dwordx4 v13, s[8:11], s27 offen lds
    s_add_u32 m0, s33, 49152
    s_nop 0
    buffer_load_dwordx4 v14, s[12:15], s28 offen lds
    s_add_u32 m0, s33, 50176
    s_nop 0
    buffer_load_dwordx4 v15, s[12:15], s28 offen lds
    s_add_u32 m0, s33, 51200
    s_nop 0
    buffer_load_dwordx4 v16, s[12:15], s28 offen lds
    s_add_u32 m0, s33, 52224
    s_nop 0
    buffer_load_dwordx4 v17, s[12:15], s28 offen lds
    s_add_u32 s27, s27, 128
    s_add_u32 s28, s28, s32
    s_waitcnt vmcnt(8)
    s_barrier
    ds_read_b128 v[32:35], v20 offset:0
    ds_read_b128 v[36:39], v20 offset:4096
    ds_read_b64_tr_b16 v[40:41], v24 offset:0
    ds_read_b64_tr_b16 v[42:43], v24 offset:1024
    ds_read_b64_tr_b16 v[44:45], v25 offset:0
    ds_read_b64_tr_b16 v[46:47], v25 offset:1024
    ds_read_b128 v[48:51], v21 offset:0
    ds_read_b128 v[52:55], v21 offset:4096
    ds_read_b64_tr_b16 v[56:57], v24 offset:4096
    ds_read_b64_tr_b16 v[58:59], v24 offset:5120
    ds_read_b64_tr_b16 v[60:61], v25 offset:4096
    ds_read_b64_tr_b16 v[62:63], v25 offset:5120
    s_waitcnt lgkmcnt(6)
    v_mfma_f32_32x32x16_bf16 v[64:79], v[40:43], v[32:35], v[64:79]
    v_mfma_f32_32x32x16_bf16 v[80:95], v[40:43], v[36:39], v[80:95]
    v_mfma_f32_32x32x16_bf16 v[96:111], v[44:47], v[32:35], v[96:111]
    v_mfma_f32_32x32x16_bf16 v[112:127], v[44:47], v[36:39], v[112:127]
    ds_read_b128 v[32:35], v22 offset:0
    ds_read_b128 v[36:39], v22 offset:4096
    ds_read_b64_tr_b16 v[40:41], v24 offset:8192
    ds_read_b64_tr_b16 v[42:43], v24 offset:9216
    ds_read_b64_tr_b16 v[44:45], v25 offset:8192
    ds_read_b64_tr_b16 v[46:47], v25 offset:9216
    s_waitcnt lgkmcnt(6)
    v_mfma_f32_32x32x16_bf16 v[64:79], v[56:59], v[48:51], v[64:79]
    v_mfma_f32_32x32x16_bf16 v[80:95], v[56:59], v[52:55], v[80:95]
    v_mfma_f32_32x32x16_bf16 v[96:111], v[60:63], v[48:51], v[96:111]
    v_mfma_f32_32x32x16_bf16 v[112:127], v[60:63], v[52:55], v[112:127]
    ds_read_b128 v[48:51], v23 offset:0
    ds_read_b128 v[52:55], v23 offset:4096
    ds_read_b64_tr_b16 v[56:57], v24 offset:12288
    ds_read_b64_tr_b16 v[58:59], v24 offset:13312
    ds_read_b64_tr_b16 v[60:61], v25 offset:12288
    ds_read_b64_tr_b16 v[62:63], v25 offset:13312
    s_waitcnt lgkmcnt(6)
    v_mfma_f32_32x32x16_bf16 v[64:79], v[40:43], v[32:35], v[64:79]
    v_mfma_f32_32x32x16_bf16 v[80:95], v[40:43], v[36:39], v[80:95]
    v_mfma_f32_32x32x16_bf16 v[96:111], v[44:47], v[32:35], v[96:111]
    v_mfma_f32_32x32x16_bf16 v[112:127], v[44:47], v[36:39], v[112:127]
    s_waitcnt lgkmcnt(0)
    v_mfma_f32_32x32x16_bf16 v[64:79], v[56:59], v[48:51], v[64:79]
    v_mfma_f32_32x32x16_bf16 v[80:95], v[56:59], v[52:55], v[80:95]
    v_mfma_f32_32x32x16_bf16 v[96:111], v[60:63], v[48:51], v[96:111]
    v_mfma_f32_32x32x16_bf16 v[112:127], v[60:63], v[52:55], v[112:127]
    s_barrier
    s_add_u32 s34, s34, 2
    s_cmp_ge_u32 s34, s23
    s_cbranch_scc1 gemm_last_13
    s_add_u32 m0, s33, 0
    s_nop 0
    buffer_load_dwordx4 v10, s[8:11], s27 offen lds
    s_add_u32 m0, s33, 1024
    s_nop 0
    buffer_load_dwordx4 v11, s[8:11], s27 offen lds
    s_add_u32 m0, s33, 2048
    s_nop 0
    buffer_load_dwordx4 v12, s[8:11], s27 offen lds
    s_add_u32 m0, s33, 3072
    s_nop 0
    buffer_load_dwordx4 v13, s[8:11], s27 offen lds
    s_add_u32 m0, s33, 16384
    s_nop 0
    buffer_load_dwordx4 v14, s[12:15], s28 offen lds
    s_add_u32 m0, s33, 17408
    s_nop 0
    buffer_load_dwordx4 v15, s[12:15], s28 offen lds
    s_add_u32 m0, s33, 18432
    s_nop 0
    buffer_load_dwordx4 v16, s[12:15], s28 offen lds
    s_add_u32 m0, s33, 19456
    s_nop 0
    buffer_load_dwordx4 v17, s[12:15], s28 offen lds
    s_add_u32 s27, s27, 128
    s_add_u32 s28, s28, s32
    s_waitcnt vmcnt(8)
    s_branch gemm_join_14
gemm_last_13:
    s_waitcnt vmcnt(0)
gemm_join_14:
    s_barrier
    ds_read_b128 v[32:35], v20 offset:32768
    ds_read_b128 v[36:39], v20 offset:36864
    ds_read_b64_tr_b16 v[40:41], v24 offset:32768
    ds_read_b64_tr_b16 v[42:43], v24 offset:33792
    ds_read_b64_tr_b16 v[44:45], v25 offset:32768
    ds_read_b64_tr_b16 v[46:47], v25 offset:33792
    ds_read_b128 v[48:51], v21 offset:32768
    ds_read_b128 v[52:55], v21 offset:36864
    ds_read_b64_tr_b16 v[56:57], v24 offset:36864
    ds_read_b64_tr_b16 v[58:59], v24 offset:37888
    ds_read_b64_tr_b16 v[60:61], v25 offset:36864
    ds_read_b64_tr_b16 v[62:63], v25 offset:37888
    s_waitcnt lgkmcnt(6)
    v_mfma_f32_32x32x16_bf16 v[64:79], v[40:43], v[32:35], v[64:79]
    v_mfma_f32_32x32x16_bf16 v[80:95], v[40:43], v[36:39], v[80:95]
    v_mfma_f32_32x32x16_bf16 v[96:111], v[44:47], v[32:35], v[96:111]
    v_mfma_f32_32x32x16_bf16 v[112:127], v[44:47], v[36:39], v[112:127]
    ds_read_b128 v[32:35], v22 offset:32768
    ds_read_b128 v[36:39], v22 offset:36864
    ds_read_b64_tr_b16 v[40:41], v24 offset:40960
    ds_read_b64_tr_b16 v[42:43], v24 offset:41984
    ds_read_b64_tr_b16 v[44:45], v25 offset:40960
    ds_read_b64_tr_b16 v[46:47], v25 offset:41984
    s_waitcnt lgkmcnt(6)
    v_mfma_f32_32x32x16_bf16 v[64:79], v[56:59], v[48:51], v[64:79]
    v_mfma_f32_32x32x16_bf16 v[80:95], v[56:59], v[52:55], v[80:95]
    v_mfma_f32_32x32x16_bf16 v[96:111], v[60:63], v[48:51], v[96:111]
    v_mfma_f32_32x32x16_bf16 v[112:127], v[60:63], v[52:55], v[112:127]
    ds_read_b128 v[48:51], v23 offset:32768
    ds_read_b128 v[52:55], v23 offset:36864
    ds_read_b64_tr_b16 v[56:57], v24 offset:45056
    ds_read_b64_tr_b16 v[58:59], v24 offset:46080
    ds_read_b64_tr_b16 v[60:61], v25 offset:45056
    ds_read_b64_tr_b16 v[62:63], v25 offset:46080
    s_waitcnt lgkmcnt(6)
    v_mfma_f32_32x32x16_bf16 v[64:79], v[40:43], v[32:35], v[64:79]
    v_mfma_f32_32x32x16_bf16 v[80:95], v[40:43], v[36:39], v[80:95]
    v_mfma_f32_32x32x16_bf16 v[96:111], v[44:47], v[32:35], v[96:111]
    v_mfma_f32_32x32x16_bf16 v[112:127], v[44:47], v[36:39], v[112:127]
    s_waitcnt lgkmcnt(0)
    v_mfma_f32_32x32x16_bf16 v[64:79], v[56:59], v[48:51], v[64:79]
    v_mfma_f32_32x32x16_bf16 v[80:95], v[56:59], v[52:55], v[80:95]
    v_mfma_f32_32x32x16_bf16 v[96:111], v[60:63], v[48:51], v[96:111]
    v_mfma_f32_32x32x16_bf16 v[112:127], v[60:63], v[52:55], v[112:127]
    s_barrier
    s_cmp_lt_u32 s34, s23
    s_cbranch_scc1 gemm_loop_12
    s_nop 15
    v_and_b32 v2, 31, v1
    s_lshl_b32 s4, s30, 6
    s_add_u32 s4, s4, s24
    v_add_u32 v2, s4, v2
    v_mul_lo_u32 v2, v2, s22
    v_lshrrev_b32 v3, 5, v1
    v_lshlrev_b32 v3, 3, v3
    s_lshl_b32 s4, s31, 6
    s_add_u32 s4, s4, s25
    s_add_u32 s4, s4, s29
    s_lshl_b32 s4, s4, 1
    v_add_u32 v3, s4, v3
    v_add_u32 v2, v2, v3
    s_lshl_b32 s5, s22, 5
    v_add_u32 v3, s5, v2

    v_cvt_pk_bf16_f32 v32, v64, v65
    v_cvt_pk_bf16_f32 v33, v66, v67
    buffer_store_dwordx2 v[32:33], v2, s[16:19], 0 offen offset:0
    v_cvt_pk_bf16_f32 v34, v68, v69
    v_cvt_pk_bf16_f32 v35, v70, v71
    buffer_store_dwordx2 v[34:35], v2, s[16:19], 0 offen offset:16
    v_cvt_pk_bf16_f32 v36, v72, v73
    v_cvt_pk_bf16_f32 v37, v74, v75
    buffer_store_dwordx2 v[36:37], v2, s[16:19], 0 offen offset:32
    v_cvt_pk_bf16_f32 v38, v76, v77
    v_cvt_pk_bf16_f32 v39, v78, v79
    buffer_store_dwordx2 v[38:39], v2, s[16:19], 0 offen offset:48
    v_cvt_pk_bf16_f32 v40, v80, v81
    v_cvt_pk_bf16_f32 v41, v82, v83
    buffer_store_dwordx2 v[40:41], v3, s[16:19], 0 offen offset:0
    v_cvt_pk_bf16_f32 v42, v84, v85
    v_cvt_pk_bf16_f32 v43, v86, v87
    buffer_store_dwordx2 v[42:43], v3, s[16:19], 0 offen offset:16
    v_cvt_pk_bf16_f32 v44, v88, v89
    v_cvt_pk_bf16_f32 v45, v90, v91
    buffer_store_dwordx2 v[44:45], v3, s[16:19], 0 offen offset:32
    v_cvt_pk_bf16_f32 v46, v92, v93
    v_cvt_pk_bf16_f32 v47, v94, v95
    buffer_store_dwordx2 v[46:47], v3, s[16:19], 0 offen offset:48
    v_cvt_pk_bf16_f32 v48, v96, v97
    v_cvt_pk_bf16_f32 v49, v98, v99
    buffer_store_dwordx2 v[48:49], v2, s[16:19], 0 offen offset:64
    v_cvt_pk_bf16_f32 v50, v100, v101
    v_cvt_pk_bf16_f32 v51, v102, v103
    buffer_store_dwordx2 v[50:51], v2, s[16:19], 0 offen offset:80
    v_cvt_pk_bf16_f32 v52, v104, v105
    v_cvt_pk_bf16_f32 v53, v106, v107
    buffer_store_dwordx2 v[52:53], v2, s[16:19], 0 offen offset:96
    v_cvt_pk_bf16_f32 v54, v108, v109
    v_cvt_pk_bf16_f32 v55, v110, v111
    buffer_store_dwordx2 v[54:55], v2, s[16:19], 0 offen offset:112
    v_cvt_pk_bf16_f32 v56, v112, v113
    v_cvt_pk_bf16_f32 v57, v114, v115
    buffer_store_dwordx2 v[56:57], v3, s[16:19], 0 offen offset:64
    v_cvt_pk_bf16_f32 v58, v116, v117
    v_cvt_pk_bf16_f32 v59, v118, v119
    buffer_store_dwordx2 v[58:59], v3, s[16:19], 0 offen offset:80
    v_cvt_pk_bf16_f32 v60, v120, v121
    v_cvt_pk_bf16_f32 v61, v122, v123
    buffer_store_dwordx2 v[60:61], v3, s[16:19], 0 offen offset:96
    v_cvt_pk_bf16_f32 v62, v124, v125
    v_cvt_pk_bf16_f32 v63, v126, v127
    buffer_store_dwordx2 v[62:63], v3, s[16:19], 0 offen offset:112
    s_cmp_eq_u32 s35, 0
    s_cbranch_scc1 gemm_nosig_15
    s_load_dwordx2 s[40:41], s[0:1], 96
    s_waitcnt lgkmcnt(0)
    s_mov_b32 s42, 0x10000000
    s_mov_b32 s43, 0x00020000
    s_waitcnt vmcnt(0)
    s_barrier
    v_cmp_eq_u32 vcc, 0, v0
    s_and_saveexec_b64 s[44:45], vcc
    s_cbranch_execz sc_16
    buffer_wbl2 sc1
    s_waitcnt vmcnt(0)
    v_mov_b32 v2, 0
    v_mov_b32 v3, 1
    buffer_atomic_add v3, v2, s[40:43], s35 offen

sc_16:
    s_mov_b64 exec, s[44:45]
gemm_nosig_15:
    s_endpgm
.globl init_kernel
.p2align 8
.type init_kernel,@function
init_kernel:
    s_load_dwordx2 s[8:9], s[0:1], 96
    s_waitcnt lgkmcnt(0)
    s_mov_b32 s10, 0x10000000
    s_mov_b32 s11, 0x00020000
    s_cmp_ge_u32 s2, 1217
    s_cbranch_scc1 init_done_17
    s_lshl_b32 s3, s2, 12
    s_add_u32 s4, s3, 0x5800000
    s_cmp_lt_u32 s2, 512
    s_cbranch_scc1 init_done_17_go
    s_sub_u32 s4, s3, 0x200000
    s_add_u32 s4, s4, 0x5a00000
    s_cmp_lt_u32 s2, 704
    s_cbranch_scc1 init_done_17_go
    s_sub_u32 s4, s3, 0x2C0000
    s_add_u32 s4, s4, 0x5b00000

init_done_17_go:
    v_lshlrev_b32 v1, 4, v0
    v_mov_b32 v2, 0
    v_mov_b32 v3, 0
    v_mov_b32 v4, 0
    v_mov_b32 v5, 0
    buffer_store_dwordx4 v[2:5], v1, s[8:11], s4 offen

init_done_17:
    s_endpgm
.globl mega_kernel
.p2align 8
.type mega_kernel,@function
mega_kernel:
    s_cmp_ge_u32 s2, 256
    s_cbranch_scc1 mega_w1
    s_setprio 3
    s_cmp_ge_u32 s2, 256
    s_cbranch_scc1 chain_done_18
    s_and_b32 s3, s2, 7
    s_lshr_b32 s4, s2, 3
    s_lshr_b32 s5, s4, 3
    s_lshl_b32 s3, s3, 2
    s_add_u32 s36, s3, s5
    s_and_b32 s37, s4, 7
    v_and_b32 v1, 63, v0
    v_lshrrev_b32 v2, 6, v0
    s_nop 0
    v_readfirstlane_b32 s38, v2
    s_nop 3

    s_load_dwordx2 s[8:9], s[0:1], 40
    s_load_dwordx2 s[12:13], s[0:1], 48
    s_load_dwordx2 s[16:17], s[0:1], 56
    s_waitcnt lgkmcnt(0)
    s_cmp_eq_u32 s38, 1
    s_cselect_b32 s8, s12, s8
    s_cselect_b32 s9, s13, s9
    s_cmp_eq_u32 s38, 2
    s_cselect_b32 s8, s16, s8
    s_cselect_b32 s9, s17, s9
    s_mov_b32 s10, 0x800000
    s_mov_b32 s11, 0x00020000

    s_load_dwordx2 s[12:13], s[0:1], 64
    s_waitcnt lgkmcnt(0)
    s_mov_b32 s14, 0x800000
    s_mov_b32 s15, 0x00020000
    s_load_dwordx2 s[16:17], s[0:1], 96
    s_waitcnt lgkmcnt(0)
    s_mov_b32 s18, 0x10000000
    s_mov_b32 s19, 0x00020000
    s_load_dwordx2 s[20:21], s[0:1], 32
    s_waitcnt lgkmcnt(0)
    s_mov_b32 s22, 0x4000
    s_mov_b32 s23, 0x00020000
    s_load_dwordx2 s[24:25], s[0:1], 96
    s_waitcnt lgkmcnt(0)
    s_add_u32 s24, s24, 0x5000000
    s_addc_u32 s25, s25, 0
    s_mov_b32 s26, 0x400000
    s_mov_b32 s27, 0x00020000
    s_load_dwordx2 s[28:29], s[0:1], 96
    s_waitcnt lgkmcnt(0)
    s_add_u32 s28, s28, 0x5400000
    s_addc_u32 s29, s29, 0
    s_mov_b32 s30, 0x400000
    s_mov_b32 s31, 0x00020000
    v_lshrrev_b32 v2, 2, v1
    v_lshlrev_b32 v2, 11, v2
    v_and_b32 v3, 3, v1
    v_lshlrev_b32 v3, 4, v3
    v_add_u32 v2, v2, v3
    s_lshl_b32 s3, s36, 18
    s_lshl_b32 s4, s37, 8
    s_add_u32 s3, s3, s4
    s_lshl_b32 s4, s38, 6
    s_add_u32 s3, s3, s4
    v_add_u32 v2, s3, v2
    s_lshl_b32 s4, s38, 13
    s_mov_b32 s5, 0

    s_add_u32 m0, s4, 0
    s_nop 0
    buffer_load_dwordx4 v2, s[12:15], s5 offen lds
    s_add_u32 s5, s5, 0x8000
    s_add_u32 m0, s4, 1024
    s_nop 0
    buffer_load_dwordx4 v2, s[12:15], s5 offen lds
    s_add_u32 s5, s5, 0x8000
    s_add_u32 m0, s4, 2048
    s_nop 0
    buffer_load_dwordx4 v2, s[12:15], s5 offen lds
    s_add_u32 s5, s5, 0x8000
    s_add_u32 m0, s4, 3072
    s_nop 0
    buffer_load_dwordx4 v2, s[12:15], s5 offen lds
    s_add_u32 s5, s5, 0x8000
    s_add_u32 m0, s4, 4096
    s_nop 0
    buffer_load_dwordx4 v2, s[12:15], s5 offen lds
    s_add_u32 s5, s5, 0x8000
    s_add_u32 m0, s4, 5120
    s_nop 0
    buffer_load_dwordx4 v2, s[12:15], s5 offen lds
    s_add_u32 s5, s5, 0x8000
    s_add_u32 m0, s4, 6144
    s_nop 0
    buffer_load_dwordx4 v2, s[12:15], s5 offen lds
    s_add_u32 s5, s5, 0x8000
    s_add_u32 m0, s4, 7168
    s_nop 0
    buffer_load_dwordx4 v2, s[12:15], s5 offen lds
    s_add_u32 s5, s5, 0x8000
    s_waitcnt vmcnt(0)
    v_lshrrev_b32 v2, 4, v1
    v_bfe_u32 v3, v1, 2, 2
    v_and_b32 v4, 3, v1
    v_lshlrev_b32 v5, 3, v2
    v_add_u32 v5, v5, v3
    v_lshlrev_b32 v6, 6, v5
    v_lshlrev_b32 v7, 3, v4
    v_add_u32 v6, v6, v7
    s_lshl_b32 s4, s38, 13
    v_add_u32 v6, s4, v6

    ds_read_b64_tr_b16 v[32:33], v6 offset:0
    ds_read_b64_tr_b16 v[34:35], v6 offset:256
    ds_read_b64_tr_b16 v[36:37], v6 offset:2048
    ds_read_b64_tr_b16 v[38:39], v6 offset:2304
    ds_read_b64_tr_b16 v[40:41], v6 offset:4096
    ds_read_b64_tr_b16 v[42:43], v6 offset:4352
    ds_read_b64_tr_b16 v[44:45], v6 offset:6144
    ds_read_b64_tr_b16 v[46:47], v6 offset:6400
    ds_read_b64_tr_b16 v[48:49], v6 offset:32
    ds_read_b64_tr_b16 v[50:51], v6 offset:288
    ds_read_b64_tr_b16 v[52:53], v6 offset:2080
    ds_read_b64_tr_b16 v[54:55], v6 offset:2336
    ds_read_b64_tr_b16 v[56:57], v6 offset:4128
    ds_read_b64_tr_b16 v[58:59], v6 offset:4384
    ds_read_b64_tr_b16 v[60:61], v6 offset:6176
    ds_read_b64_tr_b16 v[62:63], v6 offset:6432
    s_waitcnt lgkmcnt(0)
    s_barrier
    s_cmp_eq_u32 s38, 3
    s_cbranch_scc1 chain_nowp_19
    v_lshrrev_b32 v2, 1, v1
    v_lshlrev_b32 v2, 13, v2
    v_and_b32 v3, 1, v1
    v_lshlrev_b32 v3, 4, v3
    v_add_u32 v2, v2, v3
    s_lshl_b32 s3, s36, 8
    s_lshl_b32 s4, s37, 5
    s_add_u32 s3, s3, s4
    v_add_u32 v2, s3, v2
    s_lshl_b32 s4, s38, 14
    s_mov_b32 s5, 0
    v_lshlrev_b32 v6, 5, v5
    v_lshlrev_b32 v7, 3, v4
    v_add_u32 v6, v6, v7
    v_add_u32 v6, s4, v6

    s_add_u32 m0, s4, 0
    s_nop 0
    buffer_load_dwordx4 v2, s[8:11], s5 offen lds
    s_add_u32 s5, s5, 0x40000
    s_add_u32 m0, s4, 1024
    s_nop 0
    buffer_load_dwordx4 v2, s[8:11], s5 offen lds
    s_add_u32 s5, s5, 0x40000
    s_add_u32 m0, s4, 2048
    s_nop 0
    buffer_load_dwordx4 v2, s[8:11], s5 offen lds
    s_add_u32 s5, s5, 0x40000
    s_add_u32 m0, s4, 3072
    s_nop 0
    buffer_load_dwordx4 v2, s[8:11], s5 offen lds
    s_add_u32 s5, s5, 0x40000
    s_add_u32 m0, s4, 4096
    s_nop 0
    buffer_load_dwordx4 v2, s[8:11], s5 offen lds
    s_add_u32 s5, s5, 0x40000
    s_add_u32 m0, s4, 5120
    s_nop 0
    buffer_load_dwordx4 v2, s[8:11], s5 offen lds
    s_add_u32 s5, s5, 0x40000
    s_add_u32 m0, s4, 6144
    s_nop 0
    buffer_load_dwordx4 v2, s[8:11], s5 offen lds
    s_add_u32 s5, s5, 0x40000
    s_add_u32 m0, s4, 7168
    s_nop 0
    buffer_load_dwordx4 v2, s[8:11], s5 offen lds
    s_add_u32 s5, s5, 0x40000
    s_add_u32 m0, s4, 8192
    s_nop 0
    buffer_load_dwordx4 v2, s[8:11], s5 offen lds
    s_add_u32 s5, s5, 0x40000
    s_add_u32 m0, s4, 9216
    s_nop 0
    buffer_load_dwordx4 v2, s[8:11], s5 offen lds
    s_add_u32 s5, s5, 0x40000
    s_add_u32 m0, s4, 10240
    s_nop 0
    buffer_load_dwordx4 v2, s[8:11], s5 offen lds
    s_add_u32 s5, s5, 0x40000
    s_add_u32 m0, s4, 11264
    s_nop 0
    buffer_load_dwordx4 v2, s[8:11], s5 offen lds
    s_add_u32 s5, s5, 0x40000
    s_add_u32 m0, s4, 12288
    s_nop 0
    buffer_load_dwordx4 v2, s[8:11], s5 offen lds
    s_add_u32 s5, s5, 0x40000
    s_add_u32 m0, s4, 13312
    s_nop 0
    buffer_load_dwordx4 v2, s[8:11], s5 offen lds
    s_add_u32 s5, s5, 0x40000
    s_add_u32 m0, s4, 14336
    s_nop 0
    buffer_load_dwordx4 v2, s[8:11], s5 offen lds
    s_add_u32 s5, s5, 0x40000
    s_add_u32 m0, s4, 15360
    s_nop 0
    buffer_load_dwordx4 v2, s[8:11], s5 offen lds
    s_add_u32 s5, s5, 0x40000
    s_waitcnt vmcnt(0)
    ds_read_b64_tr_b16 v[64:65], v6 offset:0
    ds_read_b64_tr_b16 v[66:67], v6 offset:128
    ds_read_b64_tr_b16 v[68:69], v6 offset:1024
    ds_read_b64_tr_b16 v[70:71], v6 offset:1152
    ds_read_b64_tr_b16 v[72:73], v6 offset:2048
    ds_read_b64_tr_b16 v[74:75], v6 offset:2176
    ds_read_b64_tr_b16 v[76:77], v6 offset:3072
    ds_read_b64_tr_b16 v[78:79], v6 offset:3200
    ds_read_b64_tr_b16 v[80:81], v6 offset:4096
    ds_read_b64_tr_b16 v[82:83], v6 offset:4224
    ds_read_b64_tr_b16 v[84:85], v6 offset:5120
    ds_read_b64_tr_b16 v[86:87], v6 offset:5248
    ds_read_b64_tr_b16 v[88:89], v6 offset:6144
    ds_read_b64_tr_b16 v[90:91], v6 offset:6272
    ds_read_b64_tr_b16 v[92:93], v6 offset:7168
    ds_read_b64_tr_b16 v[94:95], v6 offset:7296
    ds_read_b64_tr_b16 v[96:97], v6 offset:8192
    ds_read_b64_tr_b16 v[98:99], v6 offset:8320
    ds_read_b64_tr_b16 v[100:101], v6 offset:9216
    ds_read_b64_tr_b16 v[102:103], v6 offset:9344
    ds_read_b64_tr_b16 v[104:105], v6 offset:10240
    ds_read_b64_tr_b16 v[106:107], v6 offset:10368
    ds_read_b64_tr_b16 v[108:109], v6 offset:11264
    ds_read_b64_tr_b16 v[110:111], v6 offset:11392
    ds_read_b64_tr_b16 v[112:113], v6 offset:12288
    ds_read_b64_tr_b16 v[114:115], v6 offset:12416
    ds_read_b64_tr_b16 v[116:117], v6 offset:13312
    ds_read_b64_tr_b16 v[118:119], v6 offset:13440
    ds_read_b64_tr_b16 v[120:121], v6 offset:14336
    ds_read_b64_tr_b16 v[122:123], v6 offset:14464
    ds_read_b64_tr_b16 v[124:125], v6 offset:15360
    ds_read_b64_tr_b16 v[126:127], v6 offset:15488
    s_waitcnt lgkmcnt(0)
    s_add_u32 m0, s4, 0
    s_nop 0
    buffer_load_dwordx4 v2, s[8:11], s5 offen lds
    s_add_u32 s5, s5, 0x40000
    s_add_u32 m0, s4, 1024
    s_nop 0
    buffer_load_dwordx4 v2, s[8:11], s5 offen lds
    s_add_u32 s5, s5, 0x40000
    s_add_u32 m0, s4, 2048
    s_nop 0
    buffer_load_dwordx4 v2, s[8:11], s5 offen lds
    s_add_u32 s5, s5, 0x40000
    s_add_u32 m0, s4, 3072
    s_nop 0
    buffer_load_dwordx4 v2, s[8:11], s5 offen lds
    s_add_u32 s5, s5, 0x40000
    s_add_u32 m0, s4, 4096
    s_nop 0
    buffer_load_dwordx4 v2, s[8:11], s5 offen lds
    s_add_u32 s5, s5, 0x40000
    s_add_u32 m0, s4, 5120
    s_nop 0
    buffer_load_dwordx4 v2, s[8:11], s5 offen lds
    s_add_u32 s5, s5, 0x40000
    s_add_u32 m0, s4, 6144
    s_nop 0
    buffer_load_dwordx4 v2, s[8:11], s5 offen lds
    s_add_u32 s5, s5, 0x40000
    s_add_u32 m0, s4, 7168
    s_nop 0
    buffer_load_dwordx4 v2, s[8:11], s5 offen lds
    s_add_u32 s5, s5, 0x40000
    s_add_u32 m0, s4, 8192
    s_nop 0
    buffer_load_dwordx4 v2, s[8:11], s5 offen lds
    s_add_u32 s5, s5, 0x40000
    s_add_u32 m0, s4, 9216
    s_nop 0
    buffer_load_dwordx4 v2, s[8:11], s5 offen lds
    s_add_u32 s5, s5, 0x40000
    s_add_u32 m0, s4, 10240
    s_nop 0
    buffer_load_dwordx4 v2, s[8:11], s5 offen lds
    s_add_u32 s5, s5, 0x40000
    s_add_u32 m0, s4, 11264
    s_nop 0
    buffer_load_dwordx4 v2, s[8:11], s5 offen lds
    s_add_u32 s5, s5, 0x40000
    s_add_u32 m0, s4, 12288
    s_nop 0
    buffer_load_dwordx4 v2, s[8:11], s5 offen lds
    s_add_u32 s5, s5, 0x40000
    s_add_u32 m0, s4, 13312
    s_nop 0
    buffer_load_dwordx4 v2, s[8:11], s5 offen lds
    s_add_u32 s5, s5, 0x40000
    s_add_u32 m0, s4, 14336
    s_nop 0
    buffer_load_dwordx4 v2, s[8:11], s5 offen lds
    s_add_u32 s5, s5, 0x40000
    s_add_u32 m0, s4, 15360
    s_nop 0
    buffer_load_dwordx4 v2, s[8:11], s5 offen lds
    s_add_u32 s5, s5, 0x40000
    s_waitcnt vmcnt(0)
    ds_read_b64_tr_b16 v[128:129], v6 offset:0
    ds_read_b64_tr_b16 v[130:131], v6 offset:128
    ds_read_b64_tr_b16 v[132:133], v6 offset:1024
    ds_read_b64_tr_b16 v[134:135], v6 offset:1152
    ds_read_b64_tr_b16 v[136:137], v6 offset:2048
    ds_read_b64_tr_b16 v[138:139], v6 offset:2176
    ds_read_b64_tr_b16 v[140:141], v6 offset:3072
    ds_read_b64_tr_b16 v[142:143], v6 offset:3200
    ds_read_b64_tr_b16 v[144:145], v6 offset:4096
    ds_read_b64_tr_b16 v[146:147], v6 offset:4224
    ds_read_b64_tr_b16 v[148:149], v6 offset:5120
    ds_read_b64_tr_b16 v[150:151], v6 offset:5248
    ds_read_b64_tr_b16 v[152:153], v6 offset:6144
    ds_read_b64_tr_b16 v[154:155], v6 offset:6272
    ds_read_b64_tr_b16 v[156:157], v6 offset:7168
    ds_read_b64_tr_b16 v[158:159], v6 offset:7296
    ds_read_b64_tr_b16 v[160:161], v6 offset:8192
    ds_read_b64_tr_b16 v[162:163], v6 offset:8320
    ds_read_b64_tr_b16 v[164:165], v6 offset:9216
    ds_read_b64_tr_b16 v[166:167], v6 offset:9344
    ds_read_b64_tr_b16 v[168:169], v6 offset:10240
    ds_read_b64_tr_b16 v[170:171], v6 offset:10368
    ds_read_b64_tr_b16 v[172:173], v6 offset:11264
    ds_read_b64_tr_b16 v[174:175], v6 offset:11392
    ds_read_b64_tr_b16 v[176:177], v6 offset:12288
    ds_read_b64_tr_b16 v[178:179], v6 offset:12416
    ds_read_b64_tr_b16 v[180:181], v6 offset:13312
    ds_read_b64_tr_b16 v[182:183], v6 offset:13440
    ds_read_b64_tr_b16 v[184:185], v6 offset:14336
    ds_read_b64_tr_b16 v[186:187], v6 offset:14464
    ds_read_b64_tr_b16 v[188:189], v6 offset:15360
    ds_read_b64_tr_b16 v[190:191], v6 offset:15488
    s_waitcnt lgkmcnt(0)
chain_nowp_19:
    s_barrier
    v_mov_b32 v2, 0
    v_mov_b32 v3, 0
    v_mov_b32 v4, 0
    v_mov_b32 v5, 0
    v_lshlrev_b32 v6, 4, v0
    v_cmp_gt_u32 vcc, 144, v0
    s_and_saveexec_b64 s[40:41], vcc
    ds_write_b128 v6, v[2:5] offset:36096
    ds_write_b128 v6, v[2:5] offset:22656
    s_mov_b64 exec, s[40:41]

    v_and_b32 v2, 7, v1
    v_mul_u32_u24 v8, 2064, v2
    v_lshrrev_b32 v3, 4, v1
    v_lshlrev_b32 v4, 4, v3
    v_add_u32 v8, v8, v4

    v_lshrrev_b32 v2, 5, v0
    v_mul_u32_u24 v9, 2064, v2
    v_and_b32 v3, 31, v0
    v_lshlrev_b32 v4, 6, v3
    v_add_u32 v9, v9, v4
    v_lshlrev_b32 v10, 12, v2
    v_lshlrev_b32 v4, 7, v3
    v_add_u32 v10, v10, v4

    v_lshrrev_b32 v2, 4, v1
    v_lshlrev_b32 v2, 3, v2
    v_and_b32 v3, 7, v1
    v_add_u32 v2, v2, v3
    v_lshlrev_b32 v11, 4, v2
    s_lshl_b32 s3, s38, 3
    s_add_u32 s3, s3, s37
    s_lshl_b32 s3, s3, 9
    s_mul_i32 s4, s36, 12288
    s_add_u32 s3, s3, s4
    s_add_u32 s3, s3, 0x5a00000
    v_add_u32 v11, s3, v11

    v_and_b32 v2, 7, v1
    v_lshlrev_b32 v12, 13, v2
    v_lshrrev_b32 v3, 4, v1
    v_lshlrev_b32 v3, 3, v3
    v_add_u32 v12, v12, v3
    s_lshl_b32 s3, s36, 8
    s_lshl_b32 s4, s37, 5
    s_add_u32 s3, s3, s4
    v_add_u32 v12, s3, v12

    v_lshlrev_b32 v13, 4, v0
    s_mul_i32 s4, s36, 12288
    s_add_u32 s4, s4, 0x5a00000
    v_add_u32 v13, s4, v13

    v_and_b32 v2, 7, v0
    v_mul_u32_u24 v14, 272, v2
    v_lshrrev_b32 v3, 5, v0
    v_lshlrev_b32 v3, 5, v3
    v_add_u32 v14, v14, v3
    v_bfe_u32 v3, v0, 3, 2
    v_lshlrev_b32 v3, 3, v3
    v_add_u32 v14, v14, v3
    v_mul_u32_u24 v15, 288, v2
    v_lshrrev_b32 v3, 5, v0
    v_lshlrev_b32 v3, 5, v3
    v_add_u32 v15, v15, v3
    v_bfe_u32 v3, v0, 3, 2
    v_lshlrev_b32 v3, 3, v3
    v_add_u32 v15, v15, v3

    v_lshrrev_b32 v2, 4, v1
    v_lshlrev_b32 v16, 13, v2
    v_and_b32 v3, 15, v1
    v_lshlrev_b32 v4, 4, v3
    v_add_u32 v16, v16, v4
    s_lshl_b32 s3, s36, 8
    v_add_u32 v16, s3, v16
    v_mul_u32_u24 v17, 272, v2
    v_add_u32 v17, v17, v4
    v_mul_u32_u24 v18, 288, v2
    v_add_u32 v18, v18, v4

    v_and_b32 v2, 7, v1
    v_mul_u32_u24 v19, 272, v2
    v_lshrrev_b32 v3, 4, v1
    v_lshlrev_b32 v4, 4, v3
    v_add_u32 v19, v19, v4
    v_and_b32 v2, 15, v1
    v_mul_u32_u24 v20, 272, v2
    v_add_u32 v20, v20, v4

    v_lshrrev_b32 v2, 4, v1
    v_lshlrev_b32 v2, 2, v2
    v_bfe_u32 v3, v1, 2, 2
    v_add_u32 v2, v2, v3
    v_mul_u32_u24 v21, 288, v2
    v_and_b32 v3, 3, v1
    v_lshlrev_b32 v3, 3, v3
    v_add_u32 v21, v21, v3
    s_lshl_b32 s3, s38, 6
    v_add_u32 v21, s3, v21

    v_and_b32 v2, 7, v1
    v_mul_u32_u24 v22, 272, v2
    v_lshrrev_b32 v3, 4, v1
    v_lshlrev_b32 v4, 3, v3
    v_add_u32 v22, v22, v4
    s_lshl_b32 s3, s38, 6
    v_add_u32 v22, s3, v22
    v_lshlrev_b32 v23, 14, v3
    v_and_b32 v2, 15, v1
    v_lshlrev_b32 v2, 2, v2
    v_add_u32 v23, v23, v2
    s_lshl_b32 s3, s37, 9
    s_lshl_b32 s4, s38, 7
    s_add_u32 s3, s3, s4
    v_add_u32 v23, s3, v23
    v_xor_b32 v2, 16, v1
    v_lshlrev_b32 v24, 2, v2
    v_xor_b32 v2, 32, v1
    v_lshlrev_b32 v25, 2, v2
    v_lshlrev_b32 v26, 7, v1

    s_mov_b32 s40, 0
chain_loop_20:
    s_cmp_eq_u32 s40, 0
    s_cbranch_scc1 chain_first_21
    s_cmp_lg_u32 s38, 0
    s_cbranch_scc1 chain_pollx_24
    s_lshl_b32 s3, s40, 15
    s_add_u32 s3, s3, 0x5b00000
    s_lshr_b32 s4, s2, 3
    s_and_b32 s4, s4, 31
    s_lshl_b32 s4, s4, 10
    s_add_u32 s3, s3, s4
    s_mov_b32 s42, 0
    v_cmp_gt_u32 vcc, 8, v1
    s_and_saveexec_b64 s[44:45], vcc

chain_poll_23:
    buffer_load_dword v192, v26, s[16:19], s3 offen sc1
    s_waitcnt vmcnt(0)
    v_cmp_ne_u32 vcc, 32, v192
    s_cbranch_vccz chain_pollx_24_r
    s_sleep 1
    s_add_u32 s42, s42, 1
    s_cmp_lt_u32 s42, 1048576
    s_cbranch_scc1 chain_poll_23

chain_pollx_24_r:
    s_mov_b64 exec, s[44:45]
chain_pollx_24:
    s_barrier
    s_lshl_b32 s3, s40, 15
    s_add_u32 s3, s3, 0x5800000

    s_lshl_b32 s4, s38, 13
    s_add_u32 s3, s3, s4
    v_lshlrev_b32 v2, 4, v1
    buffer_load_dwordx4 v[192:195], v2, s[16:19], s3 offen offset:0
    buffer_load_dwordx4 v[196:199], v2, s[16:19], s3 offen offset:1024
    buffer_load_dwordx4 v[200:203], v2, s[16:19], s3 offen offset:2048
    buffer_load_dwordx4 v[204:207], v2, s[16:19], s3 offen offset:3072
    s_add_u32 s3, s3, 4096
    buffer_load_dwordx4 v[208:211], v2, s[16:19], s3 offen offset:0
    buffer_load_dwordx4 v[212:215], v2, s[16:19], s3 offen offset:1024
    buffer_load_dwordx4 v[216:219], v2, s[16:19], s3 offen offset:2048
    buffer_load_dwordx4 v[220:223], v2, s[16:19], s3 offen offset:3072
    s_mul_i32 s4, s38, 4128
    v_lshlrev_b32 v2, 3, v1
    v_add_u32 v2, s4, v2
    s_waitcnt vmcnt(7)
    v_cvt_pk_bf16_f32 v192, v192, v193
    v_cvt_pk_bf16_f32 v193, v194, v195
    ds_write_b64 v2, v[192:193] offset:0
    s_waitcnt vmcnt(6)
    v_cvt_pk_bf16_f32 v196, v196, v197
    v_cvt_pk_bf16_f32 v197, v198, v199
    ds_write_b64 v2, v[196:197] offset:512
    s_waitcnt vmcnt(5)
    v_cvt_pk_bf16_f32 v200, v200, v201
    v_cvt_pk_bf16_f32 v201, v202, v203
    ds_write_b64 v2, v[200:201] offset:1024
    s_waitcnt vmcnt(4)
    v_cvt_pk_bf16_f32 v204, v204, v205
    v_cvt_pk_bf16_f32 v205, v206, v207
    ds_write_b64 v2, v[204:205] offset:1536
    s_waitcnt vmcnt(3)
    v_cvt_pk_bf16_f32 v208, v208, v209
    v_cvt_pk_bf16_f32 v209, v210, v211
    ds_write_b64 v2, v[208:209] offset:2064
    s_waitcnt vmcnt(2)
    v_cvt_pk_bf16_f32 v212, v212, v213
    v_cvt_pk_bf16_f32 v213, v214, v215
    ds_write_b64 v2, v[212:213] offset:2576
    s_waitcnt vmcnt(1)
    v_cvt_pk_bf16_f32 v216, v216, v217
    v_cvt_pk_bf16_f32 v217, v218, v219
    ds_write_b64 v2, v[216:217] offset:3088
    s_waitcnt vmcnt(0)
    v_cvt_pk_bf16_f32 v220, v220, v221
    v_cvt_pk_bf16_f32 v221, v222, v223
    ds_write_b64 v2, v[220:221] offset:3600
    s_branch chain_havemem_22
chain_first_21:
    v_lshrrev_b32 v2, 5, v0
    v_lshlrev_b32 v2, 11, v2
    v_and_b32 v3, 31, v0
    v_lshlrev_b32 v3, 6, v3
    v_add_u32 v2, v2, v3
    buffer_load_dwordx4 v[192:195], v2, s[20:23], 0 offen offset:0
    buffer_load_dwordx4 v[196:199], v2, s[20:23], 0 offen offset:16
    buffer_load_dwordx4 v[200:203], v2, s[20:23], 0 offen offset:32
    buffer_load_dwordx4 v[204:207], v2, s[20:23], 0 offen offset:48
    s_waitcnt vmcnt(0)
    ds_write_b128 v9, v[192:195] offset:0
    ds_write_b128 v9, v[196:199] offset:16
    ds_write_b128 v9, v[200:203] offset:32
    ds_write_b128 v9, v[204:207] offset:48
chain_havemem_22:
    s_waitcnt lgkmcnt(0)
    s_barrier
    s_cmp_eq_u32 s38, 3
    s_cbranch_scc1 chain_w3_25
    v_mov_b32 v192, 0
    v_mov_b32 v193, 0
    v_mov_b32 v194, 0
    v_mov_b32 v195, 0
    ds_read_b128 v[200:203], v8 offset:0
    ds_read_b128 v[204:207], v8 offset:64
    ds_read_b128 v[208:211], v8 offset:128
    ds_read_b128 v[212:215], v8 offset:192
    s_waitcnt lgkmcnt(3)
    v_mfma_f32_16x16x32_bf16 v[192:195], v[64:67], v[200:203], v[192:195]
    ds_read_b128 v[200:203], v8 offset:256
    s_waitcnt lgkmcnt(3)
    v_mfma_f32_16x16x32_bf16 v[192:195], v[68:71], v[204:207], v[192:195]
    ds_read_b128 v[204:207], v8 offset:320
    s_waitcnt lgkmcnt(3)
    v_mfma_f32_16x16x32_bf16 v[192:195], v[72:75], v[208:211], v[192:195]
    ds_read_b128 v[208:211], v8 offset:384
    s_waitcnt lgkmcnt(3)
    v_mfma_f32_16x16x32_bf16 v[192:195], v[76:79], v[212:215], v[192:195]
    ds_read_b128 v[212:215], v8 offset:448
    s_waitcnt lgkmcnt(3)
    v_mfma_f32_16x16x32_bf16 v[192:195], v[80:83], v[200:203], v[192:195]
    ds_read_b128 v[200:203], v8 offset:512
    s_waitcnt lgkmcnt(3)
    v_mfma_f32_16x16x32_bf16 v[192:195], v[84:87], v[204:207], v[192:195]
    ds_read_b128 v[204:207], v8 offset:576
    s_waitcnt lgkmcnt(3)
    v_mfma_f32_16x16x32_bf16 v[192:195], v[88:91], v[208:211], v[192:195]
    ds_read_b128 v[208:211], v8 offset:640
    s_waitcnt lgkmcnt(3)
    v_mfma_f32_16x16x32_bf16 v[192:195], v[92:95], v[212:215], v[192:195]
    ds_read_b128 v[212:215], v8 offset:704
    s_waitcnt lgkmcnt(3)
    v_mfma_f32_16x16x32_bf16 v[192:195], v[96:99], v[200:203], v[192:195]
    ds_read_b128 v[200:203], v8 offset:768
    s_waitcnt lgkmcnt(3)
    v_mfma_f32_16x16x32_bf16 v[192:195], v[100:103], v[204:207], v[192:195]
    ds_read_b128 v[204:207], v8 offset:832
    s_waitcnt lgkmcnt(3)
    v_mfma_f32_16x16x32_bf16 v[192:195], v[104:107], v[208:211], v[192:195]
    ds_read_b128 v[208:211], v8 offset:896
    s_waitcnt lgkmcnt(3)
    v_mfma_f32_16x16x32_bf16 v[192:195], v[108:111], v[212:215], v[192:195]
    ds_read_b128 v[212:215], v8 offset:960
    s_waitcnt lgkmcnt(3)
    v_mfma_f32_16x16x32_bf16 v[192:195], v[112:115], v[200:203], v[192:195]
    ds_read_b128 v[200:203], v8 offset:1024
    s_waitcnt lgkmcnt(3)
    v_mfma_f32_16x16x32_bf16 v[192:195], v[116:119], v[204:207], v[192:195]
    ds_read_b128 v[204:207], v8 offset:1088
    s_waitcnt lgkmcnt(3)
    v_mfma_f32_16x16x32_bf16 v[192:195], v[120:123], v[208:211], v[192:195]
    ds_read_b128 v[208:211], v8 offset:1152
    s_waitcnt lgkmcnt(3)
    v_mfma_f32_16x16x32_bf16 v[192:195], v[124:127], v[212:215], v[192:195]
    ds_read_b128 v[212:215], v8 offset:1216
    s_waitcnt lgkmcnt(3)
    v_mfma_f32_16x16x32_bf16 v[192:195], v[128:131], v[200:203], v[192:195]
    ds_read_b128 v[200:203], v8 offset:1280
    s_waitcnt lgkmcnt(3)
    v_mfma_f32_16x16x32_bf16 v[192:195], v[132:135], v[204:207], v[192:195]
    ds_read_b128 v[204:207], v8 offset:1344
    s_waitcnt lgkmcnt(3)
    v_mfma_f32_16x16x32_bf16 v[192:195], v[136:139], v[208:211], v[192:195]
    ds_read_b128 v[208:211], v8 offset:1408
    s_waitcnt lgkmcnt(3)
    v_mfma_f32_16x16x32_bf16 v[192:195], v[140:143], v[212:215], v[192:195]
    ds_read_b128 v[212:215], v8 offset:1472
    s_waitcnt lgkmcnt(3)
    v_mfma_f32_16x16x32_bf16 v[192:195], v[144:147], v[200:203], v[192:195]
    ds_read_b128 v[200:203], v8 offset:1536
    s_waitcnt lgkmcnt(3)
    v_mfma_f32_16x16x32_bf16 v[192:195], v[148:151], v[204:207], v[192:195]
    ds_read_b128 v[204:207], v8 offset:1600
    s_waitcnt lgkmcnt(3)
    v_mfma_f32_16x16x32_bf16 v[192:195], v[152:155], v[208:211], v[192:195]
    ds_read_b128 v[208:211], v8 offset:1664
    s_waitcnt lgkmcnt(3)
    v_mfma_f32_16x16x32_bf16 v[192:195], v[156:159], v[212:215], v[192:195]
    ds_read_b128 v[212:215], v8 offset:1728
    s_waitcnt lgkmcnt(3)
    v_mfma_f32_16x16x32_bf16 v[192:195], v[160:163], v[200:203], v[192:195]
    ds_read_b128 v[200:203], v8 offset:1792
    s_waitcnt lgkmcnt(3)
    v_mfma_f32_16x16x32_bf16 v[192:195], v[164:167], v[204:207], v[192:195]
    ds_read_b128 v[204:207], v8 offset:1856
    s_waitcnt lgkmcnt(3)
    v_mfma_f32_16x16x32_bf16 v[192:195], v[168:171], v[208:211], v[192:195]
    ds_read_b128 v[208:211], v8 offset:1920
    s_waitcnt lgkmcnt(3)
    v_mfma_f32_16x16x32_bf16 v[192:195], v[172:175], v[212:215], v[192:195]
    ds_read_b128 v[212:215], v8 offset:1984
    s_waitcnt lgkmcnt(3)
    v_mfma_f32_16x16x32_bf16 v[192:195], v[176:179], v[200:203], v[192:195]
    s_waitcnt lgkmcnt(2)
    v_mfma_f32_16x16x32_bf16 v[192:195], v[180:183], v[204:207], v[192:195]
    s_waitcnt lgkmcnt(1)
    v_mfma_f32_16x16x32_bf16 v[192:195], v[184:187], v[208:211], v[192:195]
    s_waitcnt lgkmcnt(0)
    v_mfma_f32_16x16x32_bf16 v[192:195], v[188:191], v[212:215], v[192:195]
    s_nop 7
    v_cvt_pk_bf16_f32 v196, v192, v193
    v_cvt_pk_bf16_f32 v198, v194, v195
    s_add_u32 s3, s40, 1
    v_mov_b32 v197, s3
    v_mov_b32 v199, s3
    v_and_b32 v2, 8, v1
    v_cmp_eq_u32 vcc, 0, v2
    s_and_saveexec_b64 s[44:45], vcc
    s_and_b32 s3, s40, 1
    s_mul_i32 s3, s3, 0x60000
    buffer_store_dwordx4 v[196:199], v11, s[16:19], s3 offen sc1
    s_cmp_eq_u32 s38, 0
    s_cbranch_scc1 chain_nokv_27
    v_mov_b32 v197, v198
    s_lshl_b32 s3, s40, 16
    s_cmp_eq_u32 s38, 2
    s_cbranch_scc1 chain_kv2_28
    buffer_store_dwordx2 v[196:197], v12, s[24:27], s3 offen
    s_branch chain_nokv_27
chain_kv2_28:
    buffer_store_dwordx2 v[196:197], v12, s[28:31], s3 offen
chain_nokv_27:
    s_mov_b64 exec, s[44:45]
    s_branch chain_pj_26
chain_w3_25:
    s_lshl_b32 s3, s40, 18
    s_add_u32 s4, s3, 0x1c00000
    s_add_u32 s5, s3, 0x2c00000

    buffer_load_dwordx4 v[192:195], v16, s[16:19], s4 offen offset:0
    s_add_u32 s4, s4, 0x8000
    buffer_load_dwordx4 v[196:199], v16, s[16:19], s4 offen offset:0
    s_add_u32 s4, s4, 0x8000
    buffer_load_dwordx4 v[200:203], v16, s[16:19], s4 offen offset:0
    s_add_u32 s4, s4, 0x8000
    buffer_load_dwordx4 v[204:207], v16, s[16:19], s4 offen offset:0
    s_add_u32 s4, s4, 0x8000
    buffer_load_dwordx4 v[208:211], v16, s[16:19], s4 offen offset:0
    s_add_u32 s4, s4, 0x8000
    buffer_load_dwordx4 v[212:215], v16, s[16:19], s4 offen offset:0
    s_add_u32 s4, s4, 0x8000
    buffer_load_dwordx4 v[216:219], v16, s[16:19], s4 offen offset:0
    s_add_u32 s4, s4, 0x8000
    buffer_load_dwordx4 v[220:223], v16, s[16:19], s4 offen offset:0
    s_add_u32 s4, s4, 0x8000
    buffer_load_dwordx4 v[224:227], v16, s[16:19], s5 offen offset:0
    s_add_u32 s5, s5, 0x8000
    buffer_load_dwordx4 v[228:231], v16, s[16:19], s5 offen offset:0
    s_add_u32 s5, s5, 0x8000
    buffer_load_dwordx4 v[232:235], v16, s[16:19], s5 offen offset:0
    s_add_u32 s5, s5, 0x8000
    buffer_load_dwordx4 v[236:239], v16, s[16:19], s5 offen offset:0
    s_add_u32 s5, s5, 0x8000
    buffer_load_dwordx4 v[240:243], v16, s[16:19], s5 offen offset:0
    s_add_u32 s5, s5, 0x8000
    buffer_load_dwordx4 v[244:247], v16, s[16:19], s5 offen offset:0
    s_add_u32 s5, s5, 0x8000
    buffer_load_dwordx4 v[248:251], v16, s[16:19], s5 offen offset:0
    s_add_u32 s5, s5, 0x8000
    buffer_load_dwordx4 v[252:255], v16, s[16:19], s5 offen offset:0
    s_add_u32 s5, s5, 0x8000
    s_waitcnt vmcnt(8)
    ds_write_b128 v17, v[192:195] offset:24832
    ds_write_b128 v17, v[196:199] offset:25920
    ds_write_b128 v17, v[200:203] offset:27008
    ds_write_b128 v17, v[204:207] offset:28096
    ds_write_b128 v17, v[208:211] offset:29184
    ds_write_b128 v17, v[212:215] offset:30272
    ds_write_b128 v17, v[216:219] offset:31360
    ds_write_b128 v17, v[220:223] offset:32448
    s_waitcnt vmcnt(0)
    ds_write_b128 v18, v[224:227] offset:38400
    ds_write_b128 v18, v[228:231] offset:39552
    ds_write_b128 v18, v[232:235] offset:40704
    ds_write_b128 v18, v[236:239] offset:41856
    ds_write_b128 v18, v[240:243] offset:43008
    ds_write_b128 v18, v[244:247] offset:44160
    ds_write_b128 v18, v[248:251] offset:45312
    ds_write_b128 v18, v[252:255] offset:46464
chain_pj_26:
    s_cmp_eq_u32 s40, 63
    s_cbranch_scc1 chain_done_18
    s_and_b32 s3, s40, 1
    s_mul_i32 s3, s3, 0x60000
    s_add_u32 s4, s40, 1
    s_mov_b32 s42, 0

chain_g1_29:
    buffer_load_dwordx4 v[192:195], v13, s[16:19], s3 offen sc1
    s_add_u32 s5, s3, 4096
    buffer_load_dwordx4 v[196:199], v13, s[16:19], s5 offen sc1
    s_add_u32 s5, s3, 8192
    buffer_load_dwordx4 v[200:203], v13, s[16:19], s5 offen sc1
    s_waitcnt vmcnt(0)
    v_cmp_ne_u32 vcc, s4, v193
    v_cmp_ne_u32 s[44:45], s4, v195
    s_or_b64 vcc, vcc, s[44:45]
    v_cmp_ne_u32 s[44:45], s4, v197
    s_or_b64 vcc, vcc, s[44:45]
    v_cmp_ne_u32 s[44:45], s4, v199
    s_or_b64 vcc, vcc, s[44:45]
    v_cmp_ne_u32 s[44:45], s4, v201
    s_or_b64 vcc, vcc, s[44:45]
    v_cmp_ne_u32 s[44:45], s4, v203
    s_or_b64 vcc, vcc, s[44:45]
    s_cbranch_vccz chain_g1x_30
    s_add_u32 s42, s42, 1
    s_cmp_lt_u32 s42, 1048576
    s_cbranch_scc1 chain_g1_29

chain_g1x_30:
    v_mov_b32 v193, v194
    v_mov_b32 v197, v198
    v_mov_b32 v201, v202
    ds_write_b64 v14, v[192:193] offset:48128
    ds_write_b64 v14, v[196:197] offset:20480
    ds_write_b64 v15, v[200:201] offset:33792
    s_waitcnt lgkmcnt(0)
    s_barrier

    ds_read_b128 v[192:195], v19 offset:48128
    ds_read_b128 v[196:199], v19 offset:48192
    ds_read_b128 v[200:203], v19 offset:48256
    ds_read_b128 v[204:207], v19 offset:48320
    v_mov_b32 v224, 0
    v_mov_b32 v225, 0
    v_mov_b32 v226, 0
    v_mov_b32 v227, 0
    v_mov_b32 v228, 0
    v_mov_b32 v229, 0
    v_mov_b32 v230, 0
    v_mov_b32 v231, 0
    v_mov_b32 v232, 0
    v_mov_b32 v233, 0
    v_mov_b32 v234, 0
    v_mov_b32 v235, 0
    ds_read_b128 v[208:211], v20 offset:20480
    ds_read_b128 v[212:215], v20 offset:20544
    ds_read_b128 v[216:219], v20 offset:20608
    ds_read_b128 v[220:223], v20 offset:20672
    s_waitcnt lgkmcnt(0)
    v_mfma_f32_16x16x32_bf16 v[224:227], v[208:211], v[192:195], v[224:227]
    v_mfma_f32_16x16x32_bf16 v[224:227], v[212:215], v[196:199], v[224:227]
    v_mfma_f32_16x16x32_bf16 v[224:227], v[216:219], v[200:203], v[224:227]
    v_mfma_f32_16x16x32_bf16 v[224:227], v[220:223], v[204:207], v[224:227]
    s_nop 7
    ds_read_b128 v[208:211], v20 offset:24832
    ds_read_b128 v[212:215], v20 offset:24896
    ds_read_b128 v[216:219], v20 offset:24960
    ds_read_b128 v[220:223], v20 offset:25024
    s_waitcnt lgkmcnt(0)
    v_mfma_f32_16x16x32_bf16 v[228:231], v[208:211], v[192:195], v[228:231]
    v_mfma_f32_16x16x32_bf16 v[228:231], v[212:215], v[196:199], v[228:231]
    v_mfma_f32_16x16x32_bf16 v[228:231], v[216:219], v[200:203], v[228:231]
    v_mfma_f32_16x16x32_bf16 v[228:231], v[220:223], v[204:207], v[228:231]
    s_nop 7
    ds_read_b128 v[208:211], v20 offset:29184
    ds_read_b128 v[212:215], v20 offset:29248
    ds_read_b128 v[216:219], v20 offset:29312
    ds_read_b128 v[220:223], v20 offset:29376
    s_waitcnt lgkmcnt(0)
    v_mfma_f32_16x16x32_bf16 v[232:235], v[208:211], v[192:195], v[232:235]
    v_mfma_f32_16x16x32_bf16 v[232:235], v[212:215], v[196:199], v[232:235]
    v_mfma_f32_16x16x32_bf16 v[232:235], v[216:219], v[200:203], v[232:235]
    v_mfma_f32_16x16x32_bf16 v[232:235], v[220:223], v[204:207], v[232:235]
    s_nop 7
    s_nop 7
    s_nop 1
    s_mov_b32 s3, 0x3db504f3
    v_cvt_pk_bf16_f32 v224, v224, v224
    v_lshlrev_b32 v224, 16, v224
    v_mul_f32 v224, s3, v224
    v_cvt_pk_bf16_f32 v224, v224, v224
    v_lshlrev_b32 v224, 16, v224
    v_cvt_pk_bf16_f32 v225, v225, v225
    v_lshlrev_b32 v225, 16, v225
    v_mul_f32 v225, s3, v225
    v_cvt_pk_bf16_f32 v225, v225, v225
    v_lshlrev_b32 v225, 16, v225
    v_cvt_pk_bf16_f32 v226, v226, v226
    v_lshlrev_b32 v226, 16, v226
    v_mul_f32 v226, s3, v226
    v_cvt_pk_bf16_f32 v226, v226, v226
    v_lshlrev_b32 v226, 16, v226
    v_cvt_pk_bf16_f32 v227, v227, v227
    v_lshlrev_b32 v227, 16, v227
    v_mul_f32 v227, s3, v227
    v_cvt_pk_bf16_f32 v227, v227, v227
    v_lshlrev_b32 v227, 16, v227
    v_cvt_pk_bf16_f32 v228, v228, v228
    v_lshlrev_b32 v228, 16, v228
    v_mul_f32 v228, s3, v228
    v_cvt_pk_bf16_f32 v228, v228, v228
    v_lshlrev_b32 v228, 16, v228
    v_cvt_pk_bf16_f32 v229, v229, v229
    v_lshlrev_b32 v229, 16, v229
    v_mul_f32 v229, s3, v229
    v_cvt_pk_bf16_f32 v229, v229, v229
    v_lshlrev_b32 v229, 16, v229
    v_cvt_pk_bf16_f32 v230, v230, v230
    v_lshlrev_b32 v230, 16, v230
    v_mul_f32 v230, s3, v230
    v_cvt_pk_bf16_f32 v230, v230, v230
    v_lshlrev_b32 v230, 16, v230
    v_cvt_pk_bf16_f32 v231, v231, v231
    v_lshlrev_b32 v231, 16, v231
    v_mul_f32 v231, s3, v231
    v_cvt_pk_bf16_f32 v231, v231, v231
    v_lshlrev_b32 v231, 16, v231
    v_cvt_pk_bf16_f32 v232, v232, v232
    v_lshlrev_b32 v232, 16, v232
    v_mul_f32 v232, s3, v232
    v_cvt_pk_bf16_f32 v232, v232, v232
    v_lshlrev_b32 v232, 16, v232
    v_cvt_pk_bf16_f32 v233, v233, v233
    v_lshlrev_b32 v233, 16, v233
    v_mul_f32 v233, s3, v233
    v_cvt_pk_bf16_f32 v233, v233, v233
    v_lshlrev_b32 v233, 16, v233
    v_cvt_pk_bf16_f32 v234, v234, v234
    v_lshlrev_b32 v234, 16, v234
    v_mul_f32 v234, s3, v234
    v_cvt_pk_bf16_f32 v234, v234, v234
    v_lshlrev_b32 v234, 16, v234
    v_cvt_pk_bf16_f32 v235, v235, v235
    v_lshlrev_b32 v235, 16, v235
    v_mul_f32 v235, s3, v235
    v_cvt_pk_bf16_f32 v235, v235, v235
    v_lshlrev_b32 v235, 16, v235
    v_mov_b32 v192, 0xff800000
    v_cmp_gt_u32 vcc, 32, v1
    v_cndmask_b32 v224, v192, v224, vcc
    v_cndmask_b32 v225, v192, v225, vcc
    v_cndmask_b32 v226, v192, v226, vcc
    v_cndmask_b32 v227, v192, v227, vcc
    v_max3_f32 v193, v224, v225, v226
    v_max3_f32 v193, v193, v227, v228
    v_max3_f32 v193, v193, v229, v230
    v_max3_f32 v193, v193, v231, v232
    v_max3_f32 v193, v193, v233, v234
    v_max_f32 v193, v193, v235
    ds_bpermute_b32 v194, v24, v193
    s_waitcnt lgkmcnt(0)
    v_max_f32 v193, v193, v194
    ds_bpermute_b32 v194, v25, v193
    s_waitcnt lgkmcnt(0)
    v_max_f32 v193, v193, v194
    s_mov_b32 s3, 0x3fb8aa3b
    v_mul_f32 v193, s3, v193
    v_mov_b32 v195, 0
    v_fma_f32 v224, v224, s3, -v193
    v_exp_f32 v224, v224
    s_nop 0
    v_add_f32 v195, v195, v224
    v_fma_f32 v225, v225, s3, -v193
    v_exp_f32 v225, v225
    s_nop 0
    v_add_f32 v195, v195, v225
    v_fma_f32 v226, v226, s3, -v193
    v_exp_f32 v226, v226
    s_nop 0
    v_add_f32 v195, v195, v226
    v_fma_f32 v227, v227, s3, -v193
    v_exp_f32 v227, v227
    s_nop 0
    v_add_f32 v195, v195, v227
    v_fma_f32 v228, v228, s3, -v193
    v_exp_f32 v228, v228
    s_nop 0
    v_add_f32 v195, v195, v228
    v_fma_f32 v229, v229, s3, -v193
    v_exp_f32 v229, v229
    s_nop 0
    v_add_f32 v195, v195, v229
    v_fma_f32 v230, v230, s3, -v193
    v_exp_f32 v230, v230
    s_nop 0
    v_add_f32 v195, v195, v230
    v_fma_f32 v231, v231, s3, -v193
    v_exp_f32 v231, v231
    s_nop 0
    v_add_f32 v195, v195, v231
    v_fma_f32 v232, v232, s3, -v193
    v_exp_f32 v232, v232
    s_nop 0
    v_add_f32 v195, v195, v232
    v_fma_f32 v233, v233, s3, -v193
    v_exp_f32 v233, v233
    s_nop 0
    v_add_f32 v195, v195, v233
    v_fma_f32 v234, v234, s3, -v193
    v_exp_f32 v234, v234
    s_nop 0
    v_add_f32 v195, v195, v234
    v_fma_f32 v235, v235, s3, -v193
    v_exp_f32 v235, v235
    s_nop 0
    v_add_f32 v195, v195, v235
    ds_bpermute_b32 v194, v24, v195
    s_waitcnt lgkmcnt(0)
    v_add_f32 v195, v195, v194
    ds_bpermute_b32 v194, v25, v195
    s_waitcnt lgkmcnt(0)
    v_add_f32 v195, v195, v194
    v_rcp_f32 v195, v195
    s_nop 0
    v_mul_f32 v224, v224, v195
    v_mul_f32 v225, v225, v195
    v_mul_f32 v226, v226, v195
    v_mul_f32 v227, v227, v195
    v_mul_f32 v228, v228, v195
    v_mul_f32 v229, v229, v195
    v_mul_f32 v230, v230, v195
    v_mul_f32 v231, v231, v195
    v_mul_f32 v232, v232, v195
    v_mul_f32 v233, v233, v195
    v_mul_f32 v234, v234, v195
    v_mul_f32 v235, v235, v195
    v_cvt_pk_bf16_f32 v196, v224, v225
    v_cvt_pk_bf16_f32 v197, v226, v227
    v_cvt_pk_bf16_f32 v198, v228, v229
    v_cvt_pk_bf16_f32 v199, v230, v231
    v_cvt_pk_bf16_f32 v200, v232, v233
    v_cvt_pk_bf16_f32 v201, v234, v235
    ds_read_b64_tr_b16 v[208:209], v21 offset:33792
    ds_read_b64_tr_b16 v[210:211], v21 offset:38400
    ds_read_b64_tr_b16 v[212:213], v21 offset:43008
    ds_read_b64_tr_b16 v[214:215], v21 offset:33824
    ds_read_b64_tr_b16 v[216:217], v21 offset:38432
    ds_read_b64_tr_b16 v[218:219], v21 offset:43040
    v_mov_b32 v224, 0
    v_mov_b32 v225, 0
    v_mov_b32 v226, 0
    v_mov_b32 v227, 0
    v_mov_b32 v228, 0
    v_mov_b32 v229, 0
    v_mov_b32 v230, 0
    v_mov_b32 v231, 0
    s_waitcnt lgkmcnt(0)
    v_mfma_f32_16x16x16_bf16 v[224:227], v[208:209], v[196:197], v[224:227]
    v_mfma_f32_16x16x16_bf16 v[224:227], v[210:211], v[198:199], v[224:227]
    v_mfma_f32_16x16x16_bf16 v[224:227], v[212:213], v[200:201], v[224:227]
    v_mfma_f32_16x16x16_bf16 v[228:231], v[214:215], v[196:197], v[228:231]
    v_mfma_f32_16x16x16_bf16 v[228:231], v[216:217], v[198:199], v[228:231]
    v_mfma_f32_16x16x16_bf16 v[228:231], v[218:219], v[200:201], v[228:231]
    s_nop 7
    s_nop 1
    v_cvt_pk_bf16_f32 v192, v224, v225
    v_cvt_pk_bf16_f32 v193, v226, v227
    ds_write_b64 v22, v[192:193] offset:51200
    v_cvt_pk_bf16_f32 v194, v228, v229
    v_cvt_pk_bf16_f32 v195, v230, v231
    ds_write_b64 v22, v[194:195] offset:51232
    s_waitcnt lgkmcnt(0)
    s_barrier
    ds_read_b128 v[192:195], v19 offset:51200
    ds_read_b128 v[196:199], v19 offset:51264
    ds_read_b128 v[200:203], v19 offset:51328
    ds_read_b128 v[204:207], v19 offset:51392
    v_mov_b32 v224, 0
    v_mov_b32 v225, 0
    v_mov_b32 v226, 0
    v_mov_b32 v227, 0
    v_mov_b32 v228, 0
    v_mov_b32 v229, 0
    v_mov_b32 v230, 0
    v_mov_b32 v231, 0
    s_waitcnt lgkmcnt(0)
    v_mfma_f32_16x16x32_bf16 v[224:227], v[192:195], v[32:35], v[224:227]
    v_mfma_f32_16x16x32_bf16 v[224:227], v[196:199], v[36:39], v[224:227]
    v_mfma_f32_16x16x32_bf16 v[224:227], v[200:203], v[40:43], v[224:227]
    v_mfma_f32_16x16x32_bf16 v[224:227], v[204:207], v[44:47], v[224:227]
    v_mfma_f32_16x16x32_bf16 v[228:231], v[192:195], v[48:51], v[228:231]
    v_mfma_f32_16x16x32_bf16 v[228:231], v[196:199], v[52:55], v[228:231]
    v_mfma_f32_16x16x32_bf16 v[228:231], v[200:203], v[56:59], v[228:231]
    v_mfma_f32_16x16x32_bf16 v[228:231], v[204:207], v[60:63], v[228:231]
    s_nop 7
    s_nop 1
    s_add_u32 s3, s40, 1
    s_lshl_b32 s3, s3, 15
    s_add_u32 s3, s3, 0x5800000
    v_cmp_gt_u32 vcc, 32, v1
    s_and_saveexec_b64 s[44:45], vcc

    buffer_atomic_add_f32 v224, v23, s[16:19], s3 offen offset:0
    s_add_u32 s3, s3, 4096
    buffer_atomic_add_f32 v225, v23, s[16:19], s3 offen offset:0
    s_add_u32 s3, s3, 4096
    buffer_atomic_add_f32 v226, v23, s[16:19], s3 offen offset:0
    s_add_u32 s3, s3, 4096
    buffer_atomic_add_f32 v227, v23, s[16:19], s3 offen offset:0
    s_sub_u32 s3, s3, 12288
    buffer_atomic_add_f32 v228, v23, s[16:19], s3 offen offset:64
    s_add_u32 s3, s3, 4096
    buffer_atomic_add_f32 v229, v23, s[16:19], s3 offen offset:64
    s_add_u32 s3, s3, 4096
    buffer_atomic_add_f32 v230, v23, s[16:19], s3 offen offset:64
    s_add_u32 s3, s3, 4096
    buffer_atomic_add_f32 v231, v23, s[16:19], s3 offen offset:64
    s_sub_u32 s3, s3, 12288
    s_mov_b64 exec, s[44:45]
    s_waitcnt vmcnt(0)
    s_barrier
    s_cmp_lg_u32 s38, 0
    s_cbranch_scc1 chain_nocnt_31
    s_add_u32 s3, s40, 1
    s_lshl_b32 s3, s3, 15
    s_and_b32 s4, s2, 7
    s_lshl_b32 s4, s4, 7
    s_add_u32 s3, s3, s4
    s_add_u32 s3, s3, 0x5b00000
    v_mov_b32 v2, 1
    v_lshlrev_b32 v3, 10, v1
    v_cmp_gt_u32 vcc, 32, v1
    s_and_saveexec_b64 s[44:45], vcc
    buffer_atomic_add v2, v3, s[16:19], s3 offen
    s_mov_b64 exec, s[44:45]

chain_nocnt_31:
    s_add_u32 s40, s40, 1
    s_branch chain_loop_20
chain_done_18:
    s_endpgm
mega_w1:
    s_sub_u32 s2, s2, 256
    s_cmp_ge_u32 s2, 896
    s_cbranch_scc1 mega_w2
    s_cmp_ge_u32 s2, 384
    s_cbranch_scc1 gemm_p_33
    s_load_dwordx2 s[8:9], s[0:1], 0
    s_waitcnt lgkmcnt(0)
    s_mov_b32 s10, 0x400000
    s_mov_b32 s11, 0x00020000
    s_load_dwordx2 s[12:13], s[0:1], 8
    s_waitcnt lgkmcnt(0)
    s_mov_b32 s14, 0x600000
    s_mov_b32 s15, 0x00020000
    s_load_dwordx2 s[16:17], s[0:1], 96
    s_waitcnt lgkmcnt(0)
    s_mov_b32 s18, 0xc00000
    s_mov_b32 s19, 0x00020000
    s_mov_b32 s20, 2048
    s_mov_b32 s21, 6144
    s_mov_b32 s22, 6144
    s_mov_b32 s23, 16
    s_sub_u32 s3, s2, 0
    s_lshr_b32 s4, s3, 3
    s_and_b32 s24, s4, 15
    s_lshr_b32 s4, s4, 4
    s_lshl_b32 s4, s4, 3
    s_and_b32 s5, s3, 7
    s_add_u32 s25, s4, s5
    s_lshl_b32 s24, s24, 7
    s_lshl_b32 s25, s25, 7
    s_mov_b32 s29, 0
    s_mov_b32 s35, 0
    s_branch gemm_body_32
gemm_p_33:
    s_cmp_ge_u32 s2, 896
    s_cbranch_scc1 gemm_p_34
    s_load_dwordx2 s[8:9], s[0:1], 24
    s_waitcnt lgkmcnt(0)
    s_mov_b32 s10, 0x400000
    s_mov_b32 s11, 0x00020000
    s_load_dwordx2 s[12:13], s[0:1], 40
    s_waitcnt lgkmcnt(0)
    s_mov_b32 s14, 0x800000
    s_mov_b32 s15, 0x00020000
    s_load_dwordx2 s[16:17], s[0:1], 96
    s_waitcnt lgkmcnt(0)
    s_add_u32 s16, s16, 0xc00000
    s_addc_u32 s17, s17, 0
    s_mov_b32 s18, 0x1000000
    s_mov_b32 s19, 0x00020000
    s_mov_b32 s20, 2048
    s_mov_b32 s21, 8192
    s_mov_b32 s22, 8192
    s_mov_b32 s23, 16
    s_sub_u32 s3, s2, 384
    s_lshr_b32 s4, s3, 3
    s_and_b32 s24, s4, 15
    s_lshr_b32 s4, s4, 4
    s_lshl_b32 s4, s4, 3
    s_and_b32 s5, s3, 7
    s_add_u32 s25, s4, s5
    s_lshl_b32 s24, s24, 7
    s_lshl_b32 s25, s25, 7
    s_mov_b32 s29, 0
    s_mov_b32 s35, 0
    s_branch gemm_body_32
gemm_p_34:
    s_endpgm
gemm_body_32:
    v_and_b32 v1, 63, v0
    v_lshrrev_b32 v2, 6, v0
    s_nop 0
    v_readfirstlane_b32 s26, v2
    s_nop 3
    s_lshr_b32 s30, s26, 1
    s_and_b32 s31, s26, 1

    v_lshrrev_b32 v2, 3, v1
    v_lshrrev_b32 v3, 4, v1
    v_and_b32 v4, 7, v1
    s_lshl_b32 s4, s26, 5
    s_add_u32 s4, s4, s24

    v_add_u32 v5, 0, v2
    v_add_u32 v5, s4, v5
    v_mul_lo_u32 v6, v5, s20
    v_add_u32 v7, 0, v3
    v_xor_b32 v7, v7, v4
    v_lshlrev_b32 v7, 4, v7
    v_add_u32 v10, v6, v7

    v_add_u32 v5, 8, v2
    v_add_u32 v5, s4, v5
    v_mul_lo_u32 v6, v5, s20
    v_add_u32 v7, 4, v3
    v_xor_b32 v7, v7, v4
    v_lshlrev_b32 v7, 4, v7
    v_add_u32 v11, v6, v7

    v_add_u32 v5, 16, v2
    v_add_u32 v5, s4, v5
    v_mul_lo_u32 v6, v5, s20
    v_add_u32 v7, 0, v3
    v_xor_b32 v7, v7, v4
    v_lshlrev_b32 v7, 4, v7
    v_add_u32 v12, v6, v7

    v_add_u32 v5, 24, v2
    v_add_u32 v5, s4, v5
    v_mul_lo_u32 v6, v5, s20
    v_add_u32 v7, 4, v3
    v_xor_b32 v7, v7, v4
    v_lshlrev_b32 v7, 4, v7
    v_add_u32 v13, v6, v7

    v_bfe_u32 v5, v1, 2, 2
    v_xor_b32 v5, v5, v3
    v_lshlrev_b32 v5, 6, v5
    v_and_b32 v6, 3, v1
    v_lshlrev_b32 v6, 4, v6
    v_add_u32 v5, v5, v6
    s_lshl_b32 s5, s25, 1
    v_add_u32 v5, s5, v5
    s_lshl_b32 s4, s26, 4

    v_add_u32 v6, 0, v3
    v_add_u32 v6, s4, v6
    v_mul_lo_u32 v6, v6, s21
    v_add_u32 v14, v6, v5

    v_add_u32 v6, 4, v3
    v_add_u32 v6, s4, v6
    v_mul_lo_u32 v6, v6, s21
    v_add_u32 v15, v6, v5

    v_add_u32 v6, 8, v3
    v_add_u32 v6, s4, v6
    v_mul_lo_u32 v6, v6, s21
    v_add_u32 v16, v6, v5

    v_add_u32 v6, 12, v3
    v_add_u32 v6, s4, v6
    v_mul_lo_u32 v6, v6, s21
    v_add_u32 v17, v6, v5

    v_and_b32 v5, 31, v1
    v_lshrrev_b32 v6, 5, v1
    s_lshl_b32 s4, s30, 6
    v_add_u32 v7, s4, v5
    v_lshlrev_b32 v7, 7, v7
    v_bfe_u32 v8, v5, 1, 3
    v_xor_b32 v8, v8, v6
    v_lshlrev_b32 v8, 4, v8
    v_add_u32 v20, v7, v8
    v_xor_b32 v21, 32, v20
    v_xor_b32 v22, 64, v20
    v_xor_b32 v23, 96, v20
    v_bfe_u32 v5, v1, 2, 2
    v_lshlrev_b32 v7, 11, v6
    v_lshlrev_b32 v8, 8, v5
    v_add_u32 v7, v7, v8
    v_bfe_u32 v8, v1, 4, 1
    v_lshlrev_b32 v8, 5, v8
    v_add_u32 v7, v7, v8
    v_and_b32 v8, 3, v1
    v_lshlrev_b32 v8, 3, v8
    v_add_u32 v7, v7, v8
    v_add_u32 v7, 0x4000, v7
    s_lshl_b32 s4, s31, 1

    s_add_u32 s5, s4, 0
    v_xor_b32 v8, s5, v5
    v_lshlrev_b32 v8, 6, v8
    v_add_u32 v24, v7, v8

    s_add_u32 s5, s4, 1
    v_xor_b32 v8, s5, v5
    v_lshlrev_b32 v8, 6, v8
    v_add_u32 v25, v7, v8

    v_mov_b32 v64, 0
    v_mov_b32 v65, 0
    v_mov_b32 v66, 0
    v_mov_b32 v67, 0
    v_mov_b32 v68, 0
    v_mov_b32 v69, 0
    v_mov_b32 v70, 0
    v_mov_b32 v71, 0
    v_mov_b32 v72, 0
    v_mov_b32 v73, 0
    v_mov_b32 v74, 0
    v_mov_b32 v75, 0
    v_mov_b32 v76, 0
    v_mov_b32 v77, 0
    v_mov_b32 v78, 0
    v_mov_b32 v79, 0
    v_mov_b32 v80, 0
    v_mov_b32 v81, 0
    v_mov_b32 v82, 0
    v_mov_b32 v83, 0
    v_mov_b32 v84, 0
    v_mov_b32 v85, 0
    v_mov_b32 v86, 0
    v_mov_b32 v87, 0
    v_mov_b32 v88, 0
    v_mov_b32 v89, 0
    v_mov_b32 v90, 0
    v_mov_b32 v91, 0
    v_mov_b32 v92, 0
    v_mov_b32 v93, 0
    v_mov_b32 v94, 0
    v_mov_b32 v95, 0
    v_mov_b32 v96, 0
    v_mov_b32 v97, 0
    v_mov_b32 v98, 0
    v_mov_b32 v99, 0
    v_mov_b32 v100, 0
    v_mov_b32 v101, 0
    v_mov_b32 v102, 0
    v_mov_b32 v103, 0
    v_mov_b32 v104, 0
    v_mov_b32 v105, 0
    v_mov_b32 v106, 0
    v_mov_b32 v107, 0
    v_mov_b32 v108, 0
    v_mov_b32 v109, 0
    v_mov_b32 v110, 0
    v_mov_b32 v111, 0
    v_mov_b32 v112, 0
    v_mov_b32 v113, 0
    v_mov_b32 v114, 0
    v_mov_b32 v115, 0
    v_mov_b32 v116, 0
    v_mov_b32 v117, 0
    v_mov_b32 v118, 0
    v_mov_b32 v119, 0
    v_mov_b32 v120, 0
    v_mov_b32 v121, 0
    v_mov_b32 v122, 0
    v_mov_b32 v123, 0
    v_mov_b32 v124, 0
    v_mov_b32 v125, 0
    v_mov_b32 v126, 0
    v_mov_b32 v127, 0
    s_mov_b32 s27, 0
    s_mov_b32 s28, 0
    s_lshl_b32 s32, s21, 6
    s_lshl_b32 s33, s26, 12
    s_add_u32 m0, s33, 0
    s_nop 0
    buffer_load_dwordx4 v10, s[8:11], s27 offen lds
    s_add_u32 m0, s33, 1024
    s_nop 0
    buffer_load_dwordx4 v11, s[8:11], s27 offen lds
    s_add_u32 m0, s33, 2048
    s_nop 0
    buffer_load_dwordx4 v12, s[8:11], s27 offen lds
    s_add_u32 m0, s33, 3072
    s_nop 0
    buffer_load_dwordx4 v13, s[8:11], s27 offen lds
    s_add_u32 m0, s33, 16384
    s_nop 0
    buffer_load_dwordx4 v14, s[12:15], s28 offen lds
    s_add_u32 m0, s33, 17408
    s_nop 0
    buffer_load_dwordx4 v15, s[12:15], s28 offen lds
    s_add_u32 m0, s33, 18432
    s_nop 0
    buffer_load_dwordx4 v16, s[12:15], s28 offen lds
    s_add_u32 m0, s33, 19456
    s_nop 0
    buffer_load_dwordx4 v17, s[12:15], s28 offen lds
    s_add_u32 s27, s27, 128
    s_add_u32 s28, s28, s32
    s_mov_b32 s34, 0
gemm_loop_35:
    s_add_u32 m0, s33, 32768
    s_nop 0
    buffer_load_dwordx4 v10, s[8:11], s27 offen lds
    s_add_u32 m0, s33, 33792
    s_nop 0
    buffer_load_dwordx4 v11, s[8:11], s27 offen lds
    s_add_u32 m0, s33, 34816
    s_nop 0
    buffer_load_dwordx4 v12, s[8:11], s27 offen lds
    s_add_u32 m0, s33, 35840
    s_nop 0
    buffer_load_dwordx4 v13, s[8:11], s27 offen lds
    s_add_u32 m0, s33, 49152
    s_nop 0
    buffer_load_dwordx4 v14, s[12:15], s28 offen lds
    s_add_u32 m0, s33, 50176
    s_nop 0
    buffer_load_dwordx4 v15, s[12:15], s28 offen lds
    s_add_u32 m0, s33, 51200
    s_nop 0
    buffer_load_dwordx4 v16, s[12:15], s28 offen lds
    s_add_u32 m0, s33, 52224
    s_nop 0
    buffer_load_dwordx4 v17, s[12:15], s28 offen lds
    s_add_u32 s27, s27, 128
    s_add_u32 s28, s28, s32
    s_waitcnt vmcnt(8)
    s_barrier
    ds_read_b128 v[32:35], v20 offset:0
    ds_read_b128 v[36:39], v20 offset:4096
    ds_read_b64_tr_b16 v[40:41], v24 offset:0
    ds_read_b64_tr_b16 v[42:43], v24 offset:1024
    ds_read_b64_tr_b16 v[44:45], v25 offset:0
    ds_read_b64_tr_b16 v[46:47], v25 offset:1024
    ds_read_b128 v[48:51], v21 offset:0
    ds_read_b128 v[52:55], v21 offset:4096
    ds_read_b64_tr_b16 v[56:57], v24 offset:4096
    ds_read_b64_tr_b16 v[58:59], v24 offset:5120
    ds_read_b64_tr_b16 v[60:61], v25 offset:4096
    ds_read_b64_tr_b16 v[62:63], v25 offset:5120
    s_waitcnt lgkmcnt(6)
    v_mfma_f32_32x32x16_bf16 v[64:79], v[40:43], v[32:35], v[64:79]
    v_mfma_f32_32x32x16_bf16 v[80:95], v[40:43], v[36:39], v[80:95]
    v_mfma_f32_32x32x16_bf16 v[96:111], v[44:47], v[32:35], v[96:111]
    v_mfma_f32_32x32x16_bf16 v[112:127], v[44:47], v[36:39], v[112:127]
    ds_read_b128 v[32:35], v22 offset:0
    ds_read_b128 v[36:39], v22 offset:4096
    ds_read_b64_tr_b16 v[40:41], v24 offset:8192
    ds_read_b64_tr_b16 v[42:43], v24 offset:9216
    ds_read_b64_tr_b16 v[44:45], v25 offset:8192
    ds_read_b64_tr_b16 v[46:47], v25 offset:9216
    s_waitcnt lgkmcnt(6)
    v_mfma_f32_32x32x16_bf16 v[64:79], v[56:59], v[48:51], v[64:79]
    v_mfma_f32_32x32x16_bf16 v[80:95], v[56:59], v[52:55], v[80:95]
    v_mfma_f32_32x32x16_bf16 v[96:111], v[60:63], v[48:51], v[96:111]
    v_mfma_f32_32x32x16_bf16 v[112:127], v[60:63], v[52:55], v[112:127]
    ds_read_b128 v[48:51], v23 offset:0
    ds_read_b128 v[52:55], v23 offset:4096
    ds_read_b64_tr_b16 v[56:57], v24 offset:12288
    ds_read_b64_tr_b16 v[58:59], v24 offset:13312
    ds_read_b64_tr_b16 v[60:61], v25 offset:12288
    ds_read_b64_tr_b16 v[62:63], v25 offset:13312
    s_waitcnt lgkmcnt(6)
    v_mfma_f32_32x32x16_bf16 v[64:79], v[40:43], v[32:35], v[64:79]
    v_mfma_f32_32x32x16_bf16 v[80:95], v[40:43], v[36:39], v[80:95]
    v_mfma_f32_32x32x16_bf16 v[96:111], v[44:47], v[32:35], v[96:111]
    v_mfma_f32_32x32x16_bf16 v[112:127], v[44:47], v[36:39], v[112:127]
    s_waitcnt lgkmcnt(0)
    v_mfma_f32_32x32x16_bf16 v[64:79], v[56:59], v[48:51], v[64:79]
    v_mfma_f32_32x32x16_bf16 v[80:95], v[56:59], v[52:55], v[80:95]
    v_mfma_f32_32x32x16_bf16 v[96:111], v[60:63], v[48:51], v[96:111]
    v_mfma_f32_32x32x16_bf16 v[112:127], v[60:63], v[52:55], v[112:127]
    s_barrier
    s_add_u32 s34, s34, 2
    s_cmp_ge_u32 s34, s23
    s_cbranch_scc1 gemm_last_36
    s_add_u32 m0, s33, 0
    s_nop 0
    buffer_load_dwordx4 v10, s[8:11], s27 offen lds
    s_add_u32 m0, s33, 1024
    s_nop 0
    buffer_load_dwordx4 v11, s[8:11], s27 offen lds
    s_add_u32 m0, s33, 2048
    s_nop 0
    buffer_load_dwordx4 v12, s[8:11], s27 offen lds
    s_add_u32 m0, s33, 3072
    s_nop 0
    buffer_load_dwordx4 v13, s[8:11], s27 offen lds
    s_add_u32 m0, s33, 16384
    s_nop 0
    buffer_load_dwordx4 v14, s[12:15], s28 offen lds
    s_add_u32 m0, s33, 17408
    s_nop 0
    buffer_load_dwordx4 v15, s[12:15], s28 offen lds
    s_add_u32 m0, s33, 18432
    s_nop 0
    buffer_load_dwordx4 v16, s[12:15], s28 offen lds
    s_add_u32 m0, s33, 19456
    s_nop 0
    buffer_load_dwordx4 v17, s[12:15], s28 offen lds
    s_add_u32 s27, s27, 128
    s_add_u32 s28, s28, s32
    s_waitcnt vmcnt(8)
    s_branch gemm_join_37
gemm_last_36:
    s_waitcnt vmcnt(0)
gemm_join_37:
    s_barrier
    ds_read_b128 v[32:35], v20 offset:32768
    ds_read_b128 v[36:39], v20 offset:36864
    ds_read_b64_tr_b16 v[40:41], v24 offset:32768
    ds_read_b64_tr_b16 v[42:43], v24 offset:33792
    ds_read_b64_tr_b16 v[44:45], v25 offset:32768
    ds_read_b64_tr_b16 v[46:47], v25 offset:33792
    ds_read_b128 v[48:51], v21 offset:32768
    ds_read_b128 v[52:55], v21 offset:36864
    ds_read_b64_tr_b16 v[56:57], v24 offset:36864
    ds_read_b64_tr_b16 v[58:59], v24 offset:37888
    ds_read_b64_tr_b16 v[60:61], v25 offset:36864
    ds_read_b64_tr_b16 v[62:63], v25 offset:37888
    s_waitcnt lgkmcnt(6)
    v_mfma_f32_32x32x16_bf16 v[64:79], v[40:43], v[32:35], v[64:79]
    v_mfma_f32_32x32x16_bf16 v[80:95], v[40:43], v[36:39], v[80:95]
    v_mfma_f32_32x32x16_bf16 v[96:111], v[44:47], v[32:35], v[96:111]
    v_mfma_f32_32x32x16_bf16 v[112:127], v[44:47], v[36:39], v[112:127]
    ds_read_b128 v[32:35], v22 offset:32768
    ds_read_b128 v[36:39], v22 offset:36864
    ds_read_b64_tr_b16 v[40:41], v24 offset:40960
    ds_read_b64_tr_b16 v[42:43], v24 offset:41984
    ds_read_b64_tr_b16 v[44:45], v25 offset:40960
    ds_read_b64_tr_b16 v[46:47], v25 offset:41984
    s_waitcnt lgkmcnt(6)
    v_mfma_f32_32x32x16_bf16 v[64:79], v[56:59], v[48:51], v[64:79]
    v_mfma_f32_32x32x16_bf16 v[80:95], v[56:59], v[52:55], v[80:95]
    v_mfma_f32_32x32x16_bf16 v[96:111], v[60:63], v[48:51], v[96:111]
    v_mfma_f32_32x32x16_bf16 v[112:127], v[60:63], v[52:55], v[112:127]
    ds_read_b128 v[48:51], v23 offset:32768
    ds_read_b128 v[52:55], v23 offset:36864
    ds_read_b64_tr_b16 v[56:57], v24 offset:45056
    ds_read_b64_tr_b16 v[58:59], v24 offset:46080
    ds_read_b64_tr_b16 v[60:61], v25 offset:45056
    ds_read_b64_tr_b16 v[62:63], v25 offset:46080
    s_waitcnt lgkmcnt(6)
    v_mfma_f32_32x32x16_bf16 v[64:79], v[40:43], v[32:35], v[64:79]
    v_mfma_f32_32x32x16_bf16 v[80:95], v[40:43], v[36:39], v[80:95]
    v_mfma_f32_32x32x16_bf16 v[96:111], v[44:47], v[32:35], v[96:111]
    v_mfma_f32_32x32x16_bf16 v[112:127], v[44:47], v[36:39], v[112:127]
    s_waitcnt lgkmcnt(0)
    v_mfma_f32_32x32x16_bf16 v[64:79], v[56:59], v[48:51], v[64:79]
    v_mfma_f32_32x32x16_bf16 v[80:95], v[56:59], v[52:55], v[80:95]
    v_mfma_f32_32x32x16_bf16 v[96:111], v[60:63], v[48:51], v[96:111]
    v_mfma_f32_32x32x16_bf16 v[112:127], v[60:63], v[52:55], v[112:127]
    s_barrier
    s_cmp_lt_u32 s34, s23
    s_cbranch_scc1 gemm_loop_35
    s_nop 15
    v_and_b32 v2, 31, v1
    s_lshl_b32 s4, s30, 6
    s_add_u32 s4, s4, s24
    v_add_u32 v2, s4, v2
    v_mul_lo_u32 v2, v2, s22
    v_lshrrev_b32 v3, 5, v1
    v_lshlrev_b32 v3, 3, v3
    s_lshl_b32 s4, s31, 6
    s_add_u32 s4, s4, s25
    s_add_u32 s4, s4, s29
    s_lshl_b32 s4, s4, 1
    v_add_u32 v3, s4, v3
    v_add_u32 v2, v2, v3
    s_lshl_b32 s5, s22, 5
    v_add_u32 v3, s5, v2

    v_cvt_pk_bf16_f32 v32, v64, v65
    v_cvt_pk_bf16_f32 v33, v66, v67
    buffer_store_dwordx2 v[32:33], v2, s[16:19], 0 offen offset:0
    v_cvt_pk_bf16_f32 v34, v68, v69
    v_cvt_pk_bf16_f32 v35, v70, v71
    buffer_store_dwordx2 v[34:35], v2, s[16:19], 0 offen offset:16
    v_cvt_pk_bf16_f32 v36, v72, v73
    v_cvt_pk_bf16_f32 v37, v74, v75
    buffer_store_dwordx2 v[36:37], v2, s[16:19], 0 offen offset:32
    v_cvt_pk_bf16_f32 v38, v76, v77
    v_cvt_pk_bf16_f32 v39, v78, v79
    buffer_store_dwordx2 v[38:39], v2, s[16:19], 0 offen offset:48
    v_cvt_pk_bf16_f32 v40, v80, v81
    v_cvt_pk_bf16_f32 v41, v82, v83
    buffer_store_dwordx2 v[40:41], v3, s[16:19], 0 offen offset:0
    v_cvt_pk_bf16_f32 v42, v84, v85
    v_cvt_pk_bf16_f32 v43, v86, v87
    buffer_store_dwordx2 v[42:43], v3, s[16:19], 0 offen offset:16
    v_cvt_pk_bf16_f32 v44, v88, v89
    v_cvt_pk_bf16_f32 v45, v90, v91
    buffer_store_dwordx2 v[44:45], v3, s[16:19], 0 offen offset:32
    v_cvt_pk_bf16_f32 v46, v92, v93
    v_cvt_pk_bf16_f32 v47, v94, v95
    buffer_store_dwordx2 v[46:47], v3, s[16:19], 0 offen offset:48
    v_cvt_pk_bf16_f32 v48, v96, v97
    v_cvt_pk_bf16_f32 v49, v98, v99
    buffer_store_dwordx2 v[48:49], v2, s[16:19], 0 offen offset:64
    v_cvt_pk_bf16_f32 v50, v100, v101
    v_cvt_pk_bf16_f32 v51, v102, v103
    buffer_store_dwordx2 v[50:51], v2, s[16:19], 0 offen offset:80
    v_cvt_pk_bf16_f32 v52, v104, v105
    v_cvt_pk_bf16_f32 v53, v106, v107
    buffer_store_dwordx2 v[52:53], v2, s[16:19], 0 offen offset:96
    v_cvt_pk_bf16_f32 v54, v108, v109
    v_cvt_pk_bf16_f32 v55, v110, v111
    buffer_store_dwordx2 v[54:55], v2, s[16:19], 0 offen offset:112
    v_cvt_pk_bf16_f32 v56, v112, v113
    v_cvt_pk_bf16_f32 v57, v114, v115
    buffer_store_dwordx2 v[56:57], v3, s[16:19], 0 offen offset:64
    v_cvt_pk_bf16_f32 v58, v116, v117
    v_cvt_pk_bf16_f32 v59, v118, v119
    buffer_store_dwordx2 v[58:59], v3, s[16:19], 0 offen offset:80
    v_cvt_pk_bf16_f32 v60, v120, v121
    v_cvt_pk_bf16_f32 v61, v122, v123
    buffer_store_dwordx2 v[60:61], v3, s[16:19], 0 offen offset:96
    v_cvt_pk_bf16_f32 v62, v124, v125
    v_cvt_pk_bf16_f32 v63, v126, v127
    buffer_store_dwordx2 v[62:63], v3, s[16:19], 0 offen offset:112
    s_cmp_eq_u32 s35, 0
    s_cbranch_scc1 gemm_nosig_38
    s_load_dwordx2 s[40:41], s[0:1], 96
    s_waitcnt lgkmcnt(0)
    s_mov_b32 s42, 0x10000000
    s_mov_b32 s43, 0x00020000
    s_waitcnt vmcnt(0)
    s_barrier
    v_cmp_eq_u32 vcc, 0, v0
    s_and_saveexec_b64 s[44:45], vcc
    s_cbranch_execz sc_39
    buffer_wbl2 sc1
    s_waitcnt vmcnt(0)
    v_mov_b32 v2, 0
    v_mov_b32 v3, 1
    buffer_atomic_add v3, v2, s[40:43], s35 offen

sc_39:
    s_mov_b64 exec, s[44:45]
gemm_nosig_38:
    s_endpgm
mega_w2:
    s_endpgm
.globl attna_kernel
.p2align 8
.type attna_kernel,@function
attna_kernel:
    s_cmp_ge_u32 s2, 512
    s_cbranch_scc1 aa_done_40
    v_and_b32 v1, 63, v0
    v_lshrrev_b32 v2, 6, v0
    s_nop 0
    v_readfirstlane_b32 s38, v2
    s_nop 3
    s_lshl_b32 s3, s2, 2
    s_add_u32 s3, s3, s38
    s_lshr_b32 s36, s3, 6
    s_and_b32 s37, s3, 63
    s_lshl_b32 s37, s37, 5

    s_load_dwordx2 s[8:9], s[0:1], 96
    s_waitcnt lgkmcnt(0)
    s_mov_b32 s10, 0xc00000
    s_mov_b32 s11, 0x00020000
    s_load_dwordx2 s[12:13], s[0:1], 96
    s_waitcnt lgkmcnt(0)
    s_add_u32 s12, s12, 0x3c00000
    s_addc_u32 s13, s13, 0
    s_mov_b32 s14, 0x400000
    s_mov_b32 s15, 0x00020000
    v_and_b32 v2, 31, v1
    v_mul_u32_u24 v3, 6144, v2
    v_lshrrev_b32 v4, 5, v1
    v_lshlrev_b32 v5, 4, v4
    v_add_u32 v3, v3, v5
    s_lshl_b32 s3, s36, 6
    v_add_u32 v3, s3, v3
    s_mul_i32 s4, s37, 6144
    buffer_load_dwordx4 v[8:11], v3, s[8:11], s4 offen
    buffer_load_dwordx4 v[12:15], v3, s[8:11], s4 offen offset:32

    v_lshrrev_b32 v2, 2, v1
    v_mul_u32_u24 v6, 6144, v2
    v_and_b32 v5, 3, v1
    v_lshlrev_b32 v5, 4, v5
    v_add_u32 v6, v6, v5
    s_add_u32 s3, s3, 4096
    v_add_u32 v6, s3, v6
    s_mul_i32 s33, s38, 18432

    s_add_u32 s5, s37, 0
    s_cmp_lt_u32 s5, 256
    s_cbranch_scc1 aa_sk_41
    s_sub_u32 s5, s5, 256
    s_mul_i32 s4, s5, 6144
    buffer_load_dwordx4 v[16:19], v3, s[8:11], s4 offen offset:2048
    buffer_load_dwordx4 v[20:23], v3, s[8:11], s4 offen offset:2080
    s_add_u32 m0, s33, 0
    s_nop 0
    buffer_load_dwordx4 v6, s[8:11], s4 offen lds
    s_add_u32 s4, s4, 98304
    s_add_u32 m0, s33, 1024
    s_nop 0
    buffer_load_dwordx4 v6, s[8:11], s4 offen lds

    v_mov_b32 v64, 0
    v_mov_b32 v65, 0
    v_mov_b32 v66, 0
    v_mov_b32 v67, 0
    v_mov_b32 v68, 0
    v_mov_b32 v69, 0
    v_mov_b32 v70, 0
    v_mov_b32 v71, 0
    v_mov_b32 v72, 0
    v_mov_b32 v73, 0
    v_mov_b32 v74, 0
    v_mov_b32 v75, 0
    v_mov_b32 v76, 0
    v_mov_b32 v77, 0
    v_mov_b32 v78, 0
    v_mov_b32 v79, 0
    s_waitcnt vmcnt(0)
    v_mfma_f32_32x32x16_bf16 v[64:79], v[16:19], v[8:11], v[64:79]
    v_mfma_f32_32x32x16_bf16 v[64:79], v[20:23], v[12:15], v[64:79]
    s_nop 7
    s_branch aa_nx_42
aa_sk_41:
    v_mov_b32 v64, 0xff800000
    v_mov_b32 v65, 0xff800000
    v_mov_b32 v66, 0xff800000
    v_mov_b32 v67, 0xff800000
    v_mov_b32 v68, 0xff800000
    v_mov_b32 v69, 0xff800000
    v_mov_b32 v70, 0xff800000
    v_mov_b32 v71, 0xff800000
    v_mov_b32 v72, 0xff800000
    v_mov_b32 v73, 0xff800000
    v_mov_b32 v74, 0xff800000
    v_mov_b32 v75, 0xff800000
    v_mov_b32 v76, 0xff800000
    v_mov_b32 v77, 0xff800000
    v_mov_b32 v78, 0xff800000
    v_mov_b32 v79, 0xff800000
aa_nx_42:
    s_add_u32 s5, s37, 32
    s_cmp_lt_u32 s5, 256
    s_cbranch_scc1 aa_sk_43
    s_sub_u32 s5, s5, 256
    s_mul_i32 s4, s5, 6144
    buffer_load_dwordx4 v[16:19], v3, s[8:11], s4 offen offset:2048
    buffer_load_dwordx4 v[20:23], v3, s[8:11], s4 offen offset:2080
    s_add_u32 m0, s33, 2048
    s_nop 0
    buffer_load_dwordx4 v6, s[8:11], s4 offen lds
    s_add_u32 s4, s4, 98304
    s_add_u32 m0, s33, 3072
    s_nop 0
    buffer_load_dwordx4 v6, s[8:11], s4 offen lds

    v_mov_b32 v80, 0
    v_mov_b32 v81, 0
    v_mov_b32 v82, 0
    v_mov_b32 v83, 0
    v_mov_b32 v84, 0
    v_mov_b32 v85, 0
    v_mov_b32 v86, 0
    v_mov_b32 v87, 0
    v_mov_b32 v88, 0
    v_mov_b32 v89, 0
    v_mov_b32 v90, 0
    v_mov_b32 v91, 0
    v_mov_b32 v92, 0
    v_mov_b32 v93, 0
    v_mov_b32 v94, 0
    v_mov_b32 v95, 0
    s_waitcnt vmcnt(0)
    v_mfma_f32_32x32x16_bf16 v[80:95], v[16:19], v[8:11], v[80:95]
    v_mfma_f32_32x32x16_bf16 v[80:95], v[20:23], v[12:15], v[80:95]
    s_nop 7
    s_branch aa_nx_44
aa_sk_43:
    v_mov_b32 v80, 0xff800000
    v_mov_b32 v81, 0xff800000
    v_mov_b32 v82, 0xff800000
    v_mov_b32 v83, 0xff800000
    v_mov_b32 v84, 0xff800000
    v_mov_b32 v85, 0xff800000
    v_mov_b32 v86, 0xff800000
    v_mov_b32 v87, 0xff800000
    v_mov_b32 v88, 0xff800000
    v_mov_b32 v89, 0xff800000
    v_mov_b32 v90, 0xff800000
    v_mov_b32 v91, 0xff800000
    v_mov_b32 v92, 0xff800000
    v_mov_b32 v93, 0xff800000
    v_mov_b32 v94, 0xff800000
    v_mov_b32 v95, 0xff800000
aa_nx_44:
    s_add_u32 s5, s37, 64
    s_cmp_lt_u32 s5, 256
    s_cbranch_scc1 aa_sk_45
    s_sub_u32 s5, s5, 256
    s_mul_i32 s4, s5, 6144
    buffer_load_dwordx4 v[16:19], v3, s[8:11], s4 offen offset:2048
    buffer_load_dwordx4 v[20:23], v3, s[8:11], s4 offen offset:2080
    s_add_u32 m0, s33, 4096
    s_nop 0
    buffer_load_dwordx4 v6, s[8:11], s4 offen lds
    s_add_u32 s4, s4, 98304
    s_add_u32 m0, s33, 5120
    s_nop 0
    buffer_load_dwordx4 v6, s[8:11], s4 offen lds

    v_mov_b32 v96, 0
    v_mov_b32 v97, 0
    v_mov_b32 v98, 0
    v_mov_b32 v99, 0
    v_mov_b32 v100, 0
    v_mov_b32 v101, 0
    v_mov_b32 v102, 0
    v_mov_b32 v103, 0
    v_mov_b32 v104, 0
    v_mov_b32 v105, 0
    v_mov_b32 v106, 0
    v_mov_b32 v107, 0
    v_mov_b32 v108, 0
    v_mov_b32 v109, 0
    v_mov_b32 v110, 0
    v_mov_b32 v111, 0
    s_waitcnt vmcnt(0)
    v_mfma_f32_32x32x16_bf16 v[96:111], v[16:19], v[8:11], v[96:111]
    v_mfma_f32_32x32x16_bf16 v[96:111], v[20:23], v[12:15], v[96:111]
    s_nop 7
    s_branch aa_nx_46
aa_sk_45:
    v_mov_b32 v96, 0xff800000
    v_mov_b32 v97, 0xff800000
    v_mov_b32 v98, 0xff800000
    v_mov_b32 v99, 0xff800000
    v_mov_b32 v100, 0xff800000
    v_mov_b32 v101, 0xff800000
    v_mov_b32 v102, 0xff800000
    v_mov_b32 v103, 0xff800000
    v_mov_b32 v104, 0xff800000
    v_mov_b32 v105, 0xff800000
    v_mov_b32 v106, 0xff800000
    v_mov_b32 v107, 0xff800000
    v_mov_b32 v108, 0xff800000
    v_mov_b32 v109, 0xff800000
    v_mov_b32 v110, 0xff800000
    v_mov_b32 v111, 0xff800000
aa_nx_46:
    s_add_u32 s5, s37, 96
    s_cmp_lt_u32 s5, 256
    s_cbranch_scc1 aa_sk_47
    s_sub_u32 s5, s5, 256
    s_mul_i32 s4, s5, 6144
    buffer_load_dwordx4 v[16:19], v3, s[8:11], s4 offen offset:2048
    buffer_load_dwordx4 v[20:23], v3, s[8:11], s4 offen offset:2080
    s_add_u32 m0, s33, 6144
    s_nop 0
    buffer_load_dwordx4 v6, s[8:11], s4 offen lds
    s_add_u32 s4, s4, 98304
    s_add_u32 m0, s33, 7168
    s_nop 0
    buffer_load_dwordx4 v6, s[8:11], s4 offen lds

    v_mov_b32 v112, 0
    v_mov_b32 v113, 0
    v_mov_b32 v114, 0
    v_mov_b32 v115, 0
    v_mov_b32 v116, 0
    v_mov_b32 v117, 0
    v_mov_b32 v118, 0
    v_mov_b32 v119, 0
    v_mov_b32 v120, 0
    v_mov_b32 v121, 0
    v_mov_b32 v122, 0
    v_mov_b32 v123, 0
    v_mov_b32 v124, 0
    v_mov_b32 v125, 0
    v_mov_b32 v126, 0
    v_mov_b32 v127, 0
    s_waitcnt vmcnt(0)
    v_mfma_f32_32x32x16_bf16 v[112:127], v[16:19], v[8:11], v[112:127]
    v_mfma_f32_32x32x16_bf16 v[112:127], v[20:23], v[12:15], v[112:127]
    s_nop 7
    s_branch aa_nx_48
aa_sk_47:
    v_mov_b32 v112, 0xff800000
    v_mov_b32 v113, 0xff800000
    v_mov_b32 v114, 0xff800000
    v_mov_b32 v115, 0xff800000
    v_mov_b32 v116, 0xff800000
    v_mov_b32 v117, 0xff800000
    v_mov_b32 v118, 0xff800000
    v_mov_b32 v119, 0xff800000
    v_mov_b32 v120, 0xff800000
    v_mov_b32 v121, 0xff800000
    v_mov_b32 v122, 0xff800000
    v_mov_b32 v123, 0xff800000
    v_mov_b32 v124, 0xff800000
    v_mov_b32 v125, 0xff800000
    v_mov_b32 v126, 0xff800000
    v_mov_b32 v127, 0xff800000
aa_nx_48:
    s_add_u32 s5, s37, 128
    s_cmp_lt_u32 s5, 256
    s_cbranch_scc1 aa_sk_49
    s_sub_u32 s5, s5, 256
    s_mul_i32 s4, s5, 6144
    buffer_load_dwordx4 v[16:19], v3, s[8:11], s4 offen offset:2048
    buffer_load_dwordx4 v[20:23], v3, s[8:11], s4 offen offset:2080
    s_add_u32 m0, s33, 8192
    s_nop 0
    buffer_load_dwordx4 v6, s[8:11], s4 offen lds
    s_add_u32 s4, s4, 98304
    s_add_u32 m0, s33, 9216
    s_nop 0
    buffer_load_dwordx4 v6, s[8:11], s4 offen lds

    v_mov_b32 v128, 0
    v_mov_b32 v129, 0
    v_mov_b32 v130, 0
    v_mov_b32 v131, 0
    v_mov_b32 v132, 0
    v_mov_b32 v133, 0
    v_mov_b32 v134, 0
    v_mov_b32 v135, 0
    v_mov_b32 v136, 0
    v_mov_b32 v137, 0
    v_mov_b32 v138, 0
    v_mov_b32 v139, 0
    v_mov_b32 v140, 0
    v_mov_b32 v141, 0
    v_mov_b32 v142, 0
    v_mov_b32 v143, 0
    s_waitcnt vmcnt(0)
    v_mfma_f32_32x32x16_bf16 v[128:143], v[16:19], v[8:11], v[128:143]
    v_mfma_f32_32x32x16_bf16 v[128:143], v[20:23], v[12:15], v[128:143]
    s_nop 7
    s_branch aa_nx_50
aa_sk_49:
    v_mov_b32 v128, 0xff800000
    v_mov_b32 v129, 0xff800000
    v_mov_b32 v130, 0xff800000
    v_mov_b32 v131, 0xff800000
    v_mov_b32 v132, 0xff800000
    v_mov_b32 v133, 0xff800000
    v_mov_b32 v134, 0xff800000
    v_mov_b32 v135, 0xff800000
    v_mov_b32 v136, 0xff800000
    v_mov_b32 v137, 0xff800000
    v_mov_b32 v138, 0xff800000
    v_mov_b32 v139, 0xff800000
    v_mov_b32 v140, 0xff800000
    v_mov_b32 v141, 0xff800000
    v_mov_b32 v142, 0xff800000
    v_mov_b32 v143, 0xff800000
aa_nx_50:
    s_add_u32 s5, s37, 160
    s_cmp_lt_u32 s5, 256
    s_cbranch_scc1 aa_sk_51
    s_sub_u32 s5, s5, 256
    s_mul_i32 s4, s5, 6144
    buffer_load_dwordx4 v[16:19], v3, s[8:11], s4 offen offset:2048
    buffer_load_dwordx4 v[20:23], v3, s[8:11], s4 offen offset:2080
    s_add_u32 m0, s33, 10240
    s_nop 0
    buffer_load_dwordx4 v6, s[8:11], s4 offen lds
    s_add_u32 s4, s4, 98304
    s_add_u32 m0, s33, 11264
    s_nop 0
    buffer_load_dwordx4 v6, s[8:11], s4 offen lds

    v_mov_b32 v144, 0
    v_mov_b32 v145, 0
    v_mov_b32 v146, 0
    v_mov_b32 v147, 0
    v_mov_b32 v148, 0
    v_mov_b32 v149, 0
    v_mov_b32 v150, 0
    v_mov_b32 v151, 0
    v_mov_b32 v152, 0
    v_mov_b32 v153, 0
    v_mov_b32 v154, 0
    v_mov_b32 v155, 0
    v_mov_b32 v156, 0
    v_mov_b32 v157, 0
    v_mov_b32 v158, 0
    v_mov_b32 v159, 0
    s_waitcnt vmcnt(0)
    v_mfma_f32_32x32x16_bf16 v[144:159], v[16:19], v[8:11], v[144:159]
    v_mfma_f32_32x32x16_bf16 v[144:159], v[20:23], v[12:15], v[144:159]
    s_nop 7
    s_branch aa_nx_52
aa_sk_51:
    v_mov_b32 v144, 0xff800000
    v_mov_b32 v145, 0xff800000
    v_mov_b32 v146, 0xff800000
    v_mov_b32 v147, 0xff800000
    v_mov_b32 v148, 0xff800000
    v_mov_b32 v149, 0xff800000
    v_mov_b32 v150, 0xff800000
    v_mov_b32 v151, 0xff800000
    v_mov_b32 v152, 0xff800000
    v_mov_b32 v153, 0xff800000
    v_mov_b32 v154, 0xff800000
    v_mov_b32 v155, 0xff800000
    v_mov_b32 v156, 0xff800000
    v_mov_b32 v157, 0xff800000
    v_mov_b32 v158, 0xff800000
    v_mov_b32 v159, 0xff800000
aa_nx_52:
    s_add_u32 s5, s37, 192
    s_cmp_lt_u32 s5, 256
    s_cbranch_scc1 aa_sk_53
    s_sub_u32 s5, s5, 256
    s_mul_i32 s4, s5, 6144
    buffer_load_dwordx4 v[16:19], v3, s[8:11], s4 offen offset:2048
    buffer_load_dwordx4 v[20:23], v3, s[8:11], s4 offen offset:2080
    s_add_u32 m0, s33, 12288
    s_nop 0
    buffer_load_dwordx4 v6, s[8:11], s4 offen lds
    s_add_u32 s4, s4, 98304
    s_add_u32 m0, s33, 13312
    s_nop 0
    buffer_load_dwordx4 v6, s[8:11], s4 offen lds

    v_mov_b32 v160, 0
    v_mov_b32 v161, 0
    v_mov_b32 v162, 0
    v_mov_b32 v163, 0
    v_mov_b32 v164, 0
    v_mov_b32 v165, 0
    v_mov_b32 v166, 0
    v_mov_b32 v167, 0
    v_mov_b32 v168, 0
    v_mov_b32 v169, 0
    v_mov_b32 v170, 0
    v_mov_b32 v171, 0
    v_mov_b32 v172, 0
    v_mov_b32 v173, 0
    v_mov_b32 v174, 0
    v_mov_b32 v175, 0
    s_waitcnt vmcnt(0)
    v_mfma_f32_32x32x16_bf16 v[160:175], v[16:19], v[8:11], v[160:175]
    v_mfma_f32_32x32x16_bf16 v[160:175], v[20:23], v[12:15], v[160:175]
    s_nop 7
    s_branch aa_nx_54
aa_sk_53:
    v_mov_b32 v160, 0xff800000
    v_mov_b32 v161, 0xff800000
    v_mov_b32 v162, 0xff800000
    v_mov_b32 v163, 0xff800000
    v_mov_b32 v164, 0xff800000
    v_mov_b32 v165, 0xff800000
    v_mov_b32 v166, 0xff800000
    v_mov_b32 v167, 0xff800000
    v_mov_b32 v168, 0xff800000
    v_mov_b32 v169, 0xff800000
    v_mov_b32 v170, 0xff800000
    v_mov_b32 v171, 0xff800000
    v_mov_b32 v172, 0xff800000
    v_mov_b32 v173, 0xff800000
    v_mov_b32 v174, 0xff800000
    v_mov_b32 v175, 0xff800000
aa_nx_54:
    s_add_u32 s5, s37, 224
    s_cmp_lt_u32 s5, 256
    s_cbranch_scc1 aa_sk_55
    s_sub_u32 s5, s5, 256
    s_mul_i32 s4, s5, 6144
    buffer_load_dwordx4 v[16:19], v3, s[8:11], s4 offen offset:2048
    buffer_load_dwordx4 v[20:23], v3, s[8:11], s4 offen offset:2080
    s_add_u32 m0, s33, 14336
    s_nop 0
    buffer_load_dwordx4 v6, s[8:11], s4 offen lds
    s_add_u32 s4, s4, 98304
    s_add_u32 m0, s33, 15360
    s_nop 0
    buffer_load_dwordx4 v6, s[8:11], s4 offen lds

    v_mov_b32 v176, 0
    v_mov_b32 v177, 0
    v_mov_b32 v178, 0
    v_mov_b32 v179, 0
    v_mov_b32 v180, 0
    v_mov_b32 v181, 0
    v_mov_b32 v182, 0
    v_mov_b32 v183, 0
    v_mov_b32 v184, 0
    v_mov_b32 v185, 0
    v_mov_b32 v186, 0
    v_mov_b32 v187, 0
    v_mov_b32 v188, 0
    v_mov_b32 v189, 0
    v_mov_b32 v190, 0
    v_mov_b32 v191, 0
    s_waitcnt vmcnt(0)
    v_mfma_f32_32x32x16_bf16 v[176:191], v[16:19], v[8:11], v[176:191]
    v_mfma_f32_32x32x16_bf16 v[176:191], v[20:23], v[12:15], v[176:191]
    s_nop 7
    s_branch aa_nx_56
aa_sk_55:
    v_mov_b32 v176, 0xff800000
    v_mov_b32 v177, 0xff800000
    v_mov_b32 v178, 0xff800000
    v_mov_b32 v179, 0xff800000
    v_mov_b32 v180, 0xff800000
    v_mov_b32 v181, 0xff800000
    v_mov_b32 v182, 0xff800000
    v_mov_b32 v183, 0xff800000
    v_mov_b32 v184, 0xff800000
    v_mov_b32 v185, 0xff800000
    v_mov_b32 v186, 0xff800000
    v_mov_b32 v187, 0xff800000
    v_mov_b32 v188, 0xff800000
    v_mov_b32 v189, 0xff800000
    v_mov_b32 v190, 0xff800000
    v_mov_b32 v191, 0xff800000
aa_nx_56:
    s_add_u32 s5, s37, 256
    s_cmp_lt_u32 s5, 256
    s_cbranch_scc1 aa_sk_57
    s_sub_u32 s5, s5, 256
    s_mul_i32 s4, s5, 6144
    buffer_load_dwordx4 v[16:19], v3, s[8:11], s4 offen offset:2048
    buffer_load_dwordx4 v[20:23], v3, s[8:11], s4 offen offset:2080
    s_add_u32 m0, s33, 16384
    s_nop 0
    buffer_load_dwordx4 v6, s[8:11], s4 offen lds
    s_add_u32 s4, s4, 98304
    s_add_u32 m0, s33, 17408
    s_nop 0
    buffer_load_dwordx4 v6, s[8:11], s4 offen lds

    v_mov_b32 v192, 0
    v_mov_b32 v193, 0
    v_mov_b32 v194, 0
    v_mov_b32 v195, 0
    v_mov_b32 v196, 0
    v_mov_b32 v197, 0
    v_mov_b32 v198, 0
    v_mov_b32 v199, 0
    v_mov_b32 v200, 0
    v_mov_b32 v201, 0
    v_mov_b32 v202, 0
    v_mov_b32 v203, 0
    v_mov_b32 v204, 0
    v_mov_b32 v205, 0
    v_mov_b32 v206, 0
    v_mov_b32 v207, 0
    s_waitcnt vmcnt(0)
    v_mfma_f32_32x32x16_bf16 v[192:207], v[16:19], v[8:11], v[192:207]
    v_mfma_f32_32x32x16_bf16 v[192:207], v[20:23], v[12:15], v[192:207]
    s_nop 7
    s_branch aa_nx_58
aa_sk_57:
    v_mov_b32 v192, 0xff800000
    v_mov_b32 v193, 0xff800000
    v_mov_b32 v194, 0xff800000
    v_mov_b32 v195, 0xff800000
    v_mov_b32 v196, 0xff800000
    v_mov_b32 v197, 0xff800000
    v_mov_b32 v198, 0xff800000
    v_mov_b32 v199, 0xff800000
    v_mov_b32 v200, 0xff800000
    v_mov_b32 v201, 0xff800000
    v_mov_b32 v202, 0xff800000
    v_mov_b32 v203, 0xff800000
    v_mov_b32 v204, 0xff800000
    v_mov_b32 v205, 0xff800000
    v_mov_b32 v206, 0xff800000
    v_mov_b32 v207, 0xff800000
aa_nx_58:
    s_nop 15
    s_mov_b32 s3, 0x3e3504f3
    v_cvt_pk_bf16_f32 v64, v64, v64
    v_lshlrev_b32 v64, 16, v64
    v_mul_f32 v64, s3, v64
    v_cvt_pk_bf16_f32 v64, v64, v64
    v_lshlrev_b32 v64, 16, v64
    v_cvt_pk_bf16_f32 v65, v65, v65
    v_lshlrev_b32 v65, 16, v65
    v_mul_f32 v65, s3, v65
    v_cvt_pk_bf16_f32 v65, v65, v65
    v_lshlrev_b32 v65, 16, v65
    v_cvt_pk_bf16_f32 v66, v66, v66
    v_lshlrev_b32 v66, 16, v66
    v_mul_f32 v66, s3, v66
    v_cvt_pk_bf16_f32 v66, v66, v66
    v_lshlrev_b32 v66, 16, v66
    v_cvt_pk_bf16_f32 v67, v67, v67
    v_lshlrev_b32 v67, 16, v67
    v_mul_f32 v67, s3, v67
    v_cvt_pk_bf16_f32 v67, v67, v67
    v_lshlrev_b32 v67, 16, v67
    v_cvt_pk_bf16_f32 v68, v68, v68
    v_lshlrev_b32 v68, 16, v68
    v_mul_f32 v68, s3, v68
    v_cvt_pk_bf16_f32 v68, v68, v68
    v_lshlrev_b32 v68, 16, v68
    v_cvt_pk_bf16_f32 v69, v69, v69
    v_lshlrev_b32 v69, 16, v69
    v_mul_f32 v69, s3, v69
    v_cvt_pk_bf16_f32 v69, v69, v69
    v_lshlrev_b32 v69, 16, v69
    v_cvt_pk_bf16_f32 v70, v70, v70
    v_lshlrev_b32 v70, 16, v70
    v_mul_f32 v70, s3, v70
    v_cvt_pk_bf16_f32 v70, v70, v70
    v_lshlrev_b32 v70, 16, v70
    v_cvt_pk_bf16_f32 v71, v71, v71
    v_lshlrev_b32 v71, 16, v71
    v_mul_f32 v71, s3, v71
    v_cvt_pk_bf16_f32 v71, v71, v71
    v_lshlrev_b32 v71, 16, v71
    v_cvt_pk_bf16_f32 v72, v72, v72
    v_lshlrev_b32 v72, 16, v72
    v_mul_f32 v72, s3, v72
    v_cvt_pk_bf16_f32 v72, v72, v72
    v_lshlrev_b32 v72, 16, v72
    v_cvt_pk_bf16_f32 v73, v73, v73
    v_lshlrev_b32 v73, 16, v73
    v_mul_f32 v73, s3, v73
    v_cvt_pk_bf16_f32 v73, v73, v73
    v_lshlrev_b32 v73, 16, v73
    v_cvt_pk_bf16_f32 v74, v74, v74
    v_lshlrev_b32 v74, 16, v74
    v_mul_f32 v74, s3, v74
    v_cvt_pk_bf16_f32 v74, v74, v74
    v_lshlrev_b32 v74, 16, v74
    v_cvt_pk_bf16_f32 v75, v75, v75
    v_lshlrev_b32 v75, 16, v75
    v_mul_f32 v75, s3, v75
    v_cvt_pk_bf16_f32 v75, v75, v75
    v_lshlrev_b32 v75, 16, v75
    v_cvt_pk_bf16_f32 v76, v76, v76
    v_lshlrev_b32 v76, 16, v76
    v_mul_f32 v76, s3, v76
    v_cvt_pk_bf16_f32 v76, v76, v76
    v_lshlrev_b32 v76, 16, v76
    v_cvt_pk_bf16_f32 v77, v77, v77
    v_lshlrev_b32 v77, 16, v77
    v_mul_f32 v77, s3, v77
    v_cvt_pk_bf16_f32 v77, v77, v77
    v_lshlrev_b32 v77, 16, v77
    v_cvt_pk_bf16_f32 v78, v78, v78
    v_lshlrev_b32 v78, 16, v78
    v_mul_f32 v78, s3, v78
    v_cvt_pk_bf16_f32 v78, v78, v78
    v_lshlrev_b32 v78, 16, v78
    v_cvt_pk_bf16_f32 v79, v79, v79
    v_lshlrev_b32 v79, 16, v79
    v_mul_f32 v79, s3, v79
    v_cvt_pk_bf16_f32 v79, v79, v79
    v_lshlrev_b32 v79, 16, v79
    v_cvt_pk_bf16_f32 v80, v80, v80
    v_lshlrev_b32 v80, 16, v80
    v_mul_f32 v80, s3, v80
    v_cvt_pk_bf16_f32 v80, v80, v80
    v_lshlrev_b32 v80, 16, v80
    v_cvt_pk_bf16_f32 v81, v81, v81
    v_lshlrev_b32 v81, 16, v81
    v_mul_f32 v81, s3, v81
    v_cvt_pk_bf16_f32 v81, v81, v81
    v_lshlrev_b32 v81, 16, v81
    v_cvt_pk_bf16_f32 v82, v82, v82
    v_lshlrev_b32 v82, 16, v82
    v_mul_f32 v82, s3, v82
    v_cvt_pk_bf16_f32 v82, v82, v82
    v_lshlrev_b32 v82, 16, v82
    v_cvt_pk_bf16_f32 v83, v83, v83
    v_lshlrev_b32 v83, 16, v83
    v_mul_f32 v83, s3, v83
    v_cvt_pk_bf16_f32 v83, v83, v83
    v_lshlrev_b32 v83, 16, v83
    v_cvt_pk_bf16_f32 v84, v84, v84
    v_lshlrev_b32 v84, 16, v84
    v_mul_f32 v84, s3, v84
    v_cvt_pk_bf16_f32 v84, v84, v84
    v_lshlrev_b32 v84, 16, v84
    v_cvt_pk_bf16_f32 v85, v85, v85
    v_lshlrev_b32 v85, 16, v85
    v_mul_f32 v85, s3, v85
    v_cvt_pk_bf16_f32 v85, v85, v85
    v_lshlrev_b32 v85, 16, v85
    v_cvt_pk_bf16_f32 v86, v86, v86
    v_lshlrev_b32 v86, 16, v86
    v_mul_f32 v86, s3, v86
    v_cvt_pk_bf16_f32 v86, v86, v86
    v_lshlrev_b32 v86, 16, v86
    v_cvt_pk_bf16_f32 v87, v87, v87
    v_lshlrev_b32 v87, 16, v87
    v_mul_f32 v87, s3, v87
    v_cvt_pk_bf16_f32 v87, v87, v87
    v_lshlrev_b32 v87, 16, v87
    v_cvt_pk_bf16_f32 v88, v88, v88
    v_lshlrev_b32 v88, 16, v88
    v_mul_f32 v88, s3, v88
    v_cvt_pk_bf16_f32 v88, v88, v88
    v_lshlrev_b32 v88, 16, v88
    v_cvt_pk_bf16_f32 v89, v89, v89
    v_lshlrev_b32 v89, 16, v89
    v_mul_f32 v89, s3, v89
    v_cvt_pk_bf16_f32 v89, v89, v89
    v_lshlrev_b32 v89, 16, v89
    v_cvt_pk_bf16_f32 v90, v90, v90
    v_lshlrev_b32 v90, 16, v90
    v_mul_f32 v90, s3, v90
    v_cvt_pk_bf16_f32 v90, v90, v90
    v_lshlrev_b32 v90, 16, v90
    v_cvt_pk_bf16_f32 v91, v91, v91
    v_lshlrev_b32 v91, 16, v91
    v_mul_f32 v91, s3, v91
    v_cvt_pk_bf16_f32 v91, v91, v91
    v_lshlrev_b32 v91, 16, v91
    v_cvt_pk_bf16_f32 v92, v92, v92
    v_lshlrev_b32 v92, 16, v92
    v_mul_f32 v92, s3, v92
    v_cvt_pk_bf16_f32 v92, v92, v92
    v_lshlrev_b32 v92, 16, v92
    v_cvt_pk_bf16_f32 v93, v93, v93
    v_lshlrev_b32 v93, 16, v93
    v_mul_f32 v93, s3, v93
    v_cvt_pk_bf16_f32 v93, v93, v93
    v_lshlrev_b32 v93, 16, v93
    v_cvt_pk_bf16_f32 v94, v94, v94
    v_lshlrev_b32 v94, 16, v94
    v_mul_f32 v94, s3, v94
    v_cvt_pk_bf16_f32 v94, v94, v94
    v_lshlrev_b32 v94, 16, v94
    v_cvt_pk_bf16_f32 v95, v95, v95
    v_lshlrev_b32 v95, 16, v95
    v_mul_f32 v95, s3, v95
    v_cvt_pk_bf16_f32 v95, v95, v95
    v_lshlrev_b32 v95, 16, v95
    v_cvt_pk_bf16_f32 v96, v96, v96
    v_lshlrev_b32 v96, 16, v96
    v_mul_f32 v96, s3, v96
    v_cvt_pk_bf16_f32 v96, v96, v96
    v_lshlrev_b32 v96, 16, v96
    v_cvt_pk_bf16_f32 v97, v97, v97
    v_lshlrev_b32 v97, 16, v97
    v_mul_f32 v97, s3, v97
    v_cvt_pk_bf16_f32 v97, v97, v97
    v_lshlrev_b32 v97, 16, v97
    v_cvt_pk_bf16_f32 v98, v98, v98
    v_lshlrev_b32 v98, 16, v98
    v_mul_f32 v98, s3, v98
    v_cvt_pk_bf16_f32 v98, v98, v98
    v_lshlrev_b32 v98, 16, v98
    v_cvt_pk_bf16_f32 v99, v99, v99
    v_lshlrev_b32 v99, 16, v99
    v_mul_f32 v99, s3, v99
    v_cvt_pk_bf16_f32 v99, v99, v99
    v_lshlrev_b32 v99, 16, v99
    v_cvt_pk_bf16_f32 v100, v100, v100
    v_lshlrev_b32 v100, 16, v100
    v_mul_f32 v100, s3, v100
    v_cvt_pk_bf16_f32 v100, v100, v100
    v_lshlrev_b32 v100, 16, v100
    v_cvt_pk_bf16_f32 v101, v101, v101
    v_lshlrev_b32 v101, 16, v101
    v_mul_f32 v101, s3, v101
    v_cvt_pk_bf16_f32 v101, v101, v101
    v_lshlrev_b32 v101, 16, v101
    v_cvt_pk_bf16_f32 v102, v102, v102
    v_lshlrev_b32 v102, 16, v102
    v_mul_f32 v102, s3, v102
    v_cvt_pk_bf16_f32 v102, v102, v102
    v_lshlrev_b32 v102, 16, v102
    v_cvt_pk_bf16_f32 v103, v103, v103
    v_lshlrev_b32 v103, 16, v103
    v_mul_f32 v103, s3, v103
    v_cvt_pk_bf16_f32 v103, v103, v103
    v_lshlrev_b32 v103, 16, v103
    v_cvt_pk_bf16_f32 v104, v104, v104
    v_lshlrev_b32 v104, 16, v104
    v_mul_f32 v104, s3, v104
    v_cvt_pk_bf16_f32 v104, v104, v104
    v_lshlrev_b32 v104, 16, v104
    v_cvt_pk_bf16_f32 v105, v105, v105
    v_lshlrev_b32 v105, 16, v105
    v_mul_f32 v105, s3, v105
    v_cvt_pk_bf16_f32 v105, v105, v105
    v_lshlrev_b32 v105, 16, v105
    v_cvt_pk_bf16_f32 v106, v106, v106
    v_lshlrev_b32 v106, 16, v106
    v_mul_f32 v106, s3, v106
    v_cvt_pk_bf16_f32 v106, v106, v106
    v_lshlrev_b32 v106, 16, v106
    v_cvt_pk_bf16_f32 v107, v107, v107
    v_lshlrev_b32 v107, 16, v107
    v_mul_f32 v107, s3, v107
    v_cvt_pk_bf16_f32 v107, v107, v107
    v_lshlrev_b32 v107, 16, v107
    v_cvt_pk_bf16_f32 v108, v108, v108
    v_lshlrev_b32 v108, 16, v108
    v_mul_f32 v108, s3, v108
    v_cvt_pk_bf16_f32 v108, v108, v108
    v_lshlrev_b32 v108, 16, v108
    v_cvt_pk_bf16_f32 v109, v109, v109
    v_lshlrev_b32 v109, 16, v109
    v_mul_f32 v109, s3, v109
    v_cvt_pk_bf16_f32 v109, v109, v109
    v_lshlrev_b32 v109, 16, v109
    v_cvt_pk_bf16_f32 v110, v110, v110
    v_lshlrev_b32 v110, 16, v110
    v_mul_f32 v110, s3, v110
    v_cvt_pk_bf16_f32 v110, v110, v110
    v_lshlrev_b32 v110, 16, v110
    v_cvt_pk_bf16_f32 v111, v111, v111
    v_lshlrev_b32 v111, 16, v111
    v_mul_f32 v111, s3, v111
    v_cvt_pk_bf16_f32 v111, v111, v111
    v_lshlrev_b32 v111, 16, v111
    v_cvt_pk_bf16_f32 v112, v112, v112
    v_lshlrev_b32 v112, 16, v112
    v_mul_f32 v112, s3, v112
    v_cvt_pk_bf16_f32 v112, v112, v112
    v_lshlrev_b32 v112, 16, v112
    v_cvt_pk_bf16_f32 v113, v113, v113
    v_lshlrev_b32 v113, 16, v113
    v_mul_f32 v113, s3, v113
    v_cvt_pk_bf16_f32 v113, v113, v113
    v_lshlrev_b32 v113, 16, v113
    v_cvt_pk_bf16_f32 v114, v114, v114
    v_lshlrev_b32 v114, 16, v114
    v_mul_f32 v114, s3, v114
    v_cvt_pk_bf16_f32 v114, v114, v114
    v_lshlrev_b32 v114, 16, v114
    v_cvt_pk_bf16_f32 v115, v115, v115
    v_lshlrev_b32 v115, 16, v115
    v_mul_f32 v115, s3, v115
    v_cvt_pk_bf16_f32 v115, v115, v115
    v_lshlrev_b32 v115, 16, v115
    v_cvt_pk_bf16_f32 v116, v116, v116
    v_lshlrev_b32 v116, 16, v116
    v_mul_f32 v116, s3, v116
    v_cvt_pk_bf16_f32 v116, v116, v116
    v_lshlrev_b32 v116, 16, v116
    v_cvt_pk_bf16_f32 v117, v117, v117
    v_lshlrev_b32 v117, 16, v117
    v_mul_f32 v117, s3, v117
    v_cvt_pk_bf16_f32 v117, v117, v117
    v_lshlrev_b32 v117, 16, v117
    v_cvt_pk_bf16_f32 v118, v118, v118
    v_lshlrev_b32 v118, 16, v118
    v_mul_f32 v118, s3, v118
    v_cvt_pk_bf16_f32 v118, v118, v118
    v_lshlrev_b32 v118, 16, v118
    v_cvt_pk_bf16_f32 v119, v119, v119
    v_lshlrev_b32 v119, 16, v119
    v_mul_f32 v119, s3, v119
    v_cvt_pk_bf16_f32 v119, v119, v119
    v_lshlrev_b32 v119, 16, v119
    v_cvt_pk_bf16_f32 v120, v120, v120
    v_lshlrev_b32 v120, 16, v120
    v_mul_f32 v120, s3, v120
    v_cvt_pk_bf16_f32 v120, v120, v120
    v_lshlrev_b32 v120, 16, v120
    v_cvt_pk_bf16_f32 v121, v121, v121
    v_lshlrev_b32 v121, 16, v121
    v_mul_f32 v121, s3, v121
    v_cvt_pk_bf16_f32 v121, v121, v121
    v_lshlrev_b32 v121, 16, v121
    v_cvt_pk_bf16_f32 v122, v122, v122
    v_lshlrev_b32 v122, 16, v122
    v_mul_f32 v122, s3, v122
    v_cvt_pk_bf16_f32 v122, v122, v122
    v_lshlrev_b32 v122, 16, v122
    v_cvt_pk_bf16_f32 v123, v123, v123
    v_lshlrev_b32 v123, 16, v123
    v_mul_f32 v123, s3, v123
    v_cvt_pk_bf16_f32 v123, v123, v123
    v_lshlrev_b32 v123, 16, v123
    v_cvt_pk_bf16_f32 v124, v124, v124
    v_lshlrev_b32 v124, 16, v124
    v_mul_f32 v124, s3, v124
    v_cvt_pk_bf16_f32 v124, v124, v124
    v_lshlrev_b32 v124, 16, v124
    v_cvt_pk_bf16_f32 v125, v125, v125
    v_lshlrev_b32 v125, 16, v125
    v_mul_f32 v125, s3, v125
    v_cvt_pk_bf16_f32 v125, v125, v125
    v_lshlrev_b32 v125, 16, v125
    v_cvt_pk_bf16_f32 v126, v126, v126
    v_lshlrev_b32 v126, 16, v126
    v_mul_f32 v126, s3, v126
    v_cvt_pk_bf16_f32 v126, v126, v126
    v_lshlrev_b32 v126, 16, v126
    v_cvt_pk_bf16_f32 v127, v127, v127
    v_lshlrev_b32 v127, 16, v127
    v_mul_f32 v127, s3, v127
    v_cvt_pk_bf16_f32 v127, v127, v127
    v_lshlrev_b32 v127, 16, v127
    v_cvt_pk_bf16_f32 v128, v128, v128
    v_lshlrev_b32 v128, 16, v128
    v_mul_f32 v128, s3, v128
    v_cvt_pk_bf16_f32 v128, v128, v128
    v_lshlrev_b32 v128, 16, v128
    v_cvt_pk_bf16_f32 v129, v129, v129
    v_lshlrev_b32 v129, 16, v129
    v_mul_f32 v129, s3, v129
    v_cvt_pk_bf16_f32 v129, v129, v129
    v_lshlrev_b32 v129, 16, v129
    v_cvt_pk_bf16_f32 v130, v130, v130
    v_lshlrev_b32 v130, 16, v130
    v_mul_f32 v130, s3, v130
    v_cvt_pk_bf16_f32 v130, v130, v130
    v_lshlrev_b32 v130, 16, v130
    v_cvt_pk_bf16_f32 v131, v131, v131
    v_lshlrev_b32 v131, 16, v131
    v_mul_f32 v131, s3, v131
    v_cvt_pk_bf16_f32 v131, v131, v131
    v_lshlrev_b32 v131, 16, v131
    v_cvt_pk_bf16_f32 v132, v132, v132
    v_lshlrev_b32 v132, 16, v132
    v_mul_f32 v132, s3, v132
    v_cvt_pk_bf16_f32 v132, v132, v132
    v_lshlrev_b32 v132, 16, v132
    v_cvt_pk_bf16_f32 v133, v133, v133
    v_lshlrev_b32 v133, 16, v133
    v_mul_f32 v133, s3, v133
    v_cvt_pk_bf16_f32 v133, v133, v133
    v_lshlrev_b32 v133, 16, v133
    v_cvt_pk_bf16_f32 v134, v134, v134
    v_lshlrev_b32 v134, 16, v134
    v_mul_f32 v134, s3, v134
    v_cvt_pk_bf16_f32 v134, v134, v134
    v_lshlrev_b32 v134, 16, v134
    v_cvt_pk_bf16_f32 v135, v135, v135
    v_lshlrev_b32 v135, 16, v135
    v_mul_f32 v135, s3, v135
    v_cvt_pk_bf16_f32 v135, v135, v135
    v_lshlrev_b32 v135, 16, v135
    v_cvt_pk_bf16_f32 v136, v136, v136
    v_lshlrev_b32 v136, 16, v136
    v_mul_f32 v136, s3, v136
    v_cvt_pk_bf16_f32 v136, v136, v136
    v_lshlrev_b32 v136, 16, v136
    v_cvt_pk_bf16_f32 v137, v137, v137
    v_lshlrev_b32 v137, 16, v137
    v_mul_f32 v137, s3, v137
    v_cvt_pk_bf16_f32 v137, v137, v137
    v_lshlrev_b32 v137, 16, v137
    v_cvt_pk_bf16_f32 v138, v138, v138
    v_lshlrev_b32 v138, 16, v138
    v_mul_f32 v138, s3, v138
    v_cvt_pk_bf16_f32 v138, v138, v138
    v_lshlrev_b32 v138, 16, v138
    v_cvt_pk_bf16_f32 v139, v139, v139
    v_lshlrev_b32 v139, 16, v139
    v_mul_f32 v139, s3, v139
    v_cvt_pk_bf16_f32 v139, v139, v139
    v_lshlrev_b32 v139, 16, v139
    v_cvt_pk_bf16_f32 v140, v140, v140
    v_lshlrev_b32 v140, 16, v140
    v_mul_f32 v140, s3, v140
    v_cvt_pk_bf16_f32 v140, v140, v140
    v_lshlrev_b32 v140, 16, v140
    v_cvt_pk_bf16_f32 v141, v141, v141
    v_lshlrev_b32 v141, 16, v141
    v_mul_f32 v141, s3, v141
    v_cvt_pk_bf16_f32 v141, v141, v141
    v_lshlrev_b32 v141, 16, v141
    v_cvt_pk_bf16_f32 v142, v142, v142
    v_lshlrev_b32 v142, 16, v142
    v_mul_f32 v142, s3, v142
    v_cvt_pk_bf16_f32 v142, v142, v142
    v_lshlrev_b32 v142, 16, v142
    v_cvt_pk_bf16_f32 v143, v143, v143
    v_lshlrev_b32 v143, 16, v143
    v_mul_f32 v143, s3, v143
    v_cvt_pk_bf16_f32 v143, v143, v143
    v_lshlrev_b32 v143, 16, v143
    v_cvt_pk_bf16_f32 v144, v144, v144
    v_lshlrev_b32 v144, 16, v144
    v_mul_f32 v144, s3, v144
    v_cvt_pk_bf16_f32 v144, v144, v144
    v_lshlrev_b32 v144, 16, v144
    v_cvt_pk_bf16_f32 v145, v145, v145
    v_lshlrev_b32 v145, 16, v145
    v_mul_f32 v145, s3, v145
    v_cvt_pk_bf16_f32 v145, v145, v145
    v_lshlrev_b32 v145, 16, v145
    v_cvt_pk_bf16_f32 v146, v146, v146
    v_lshlrev_b32 v146, 16, v146
    v_mul_f32 v146, s3, v146
    v_cvt_pk_bf16_f32 v146, v146, v146
    v_lshlrev_b32 v146, 16, v146
    v_cvt_pk_bf16_f32 v147, v147, v147
    v_lshlrev_b32 v147, 16, v147
    v_mul_f32 v147, s3, v147
    v_cvt_pk_bf16_f32 v147, v147, v147
    v_lshlrev_b32 v147, 16, v147
    v_cvt_pk_bf16_f32 v148, v148, v148
    v_lshlrev_b32 v148, 16, v148
    v_mul_f32 v148, s3, v148
    v_cvt_pk_bf16_f32 v148, v148, v148
    v_lshlrev_b32 v148, 16, v148
    v_cvt_pk_bf16_f32 v149, v149, v149
    v_lshlrev_b32 v149, 16, v149
    v_mul_f32 v149, s3, v149
    v_cvt_pk_bf16_f32 v149, v149, v149
    v_lshlrev_b32 v149, 16, v149
    v_cvt_pk_bf16_f32 v150, v150, v150
    v_lshlrev_b32 v150, 16, v150
    v_mul_f32 v150, s3, v150
    v_cvt_pk_bf16_f32 v150, v150, v150
    v_lshlrev_b32 v150, 16, v150
    v_cvt_pk_bf16_f32 v151, v151, v151
    v_lshlrev_b32 v151, 16, v151
    v_mul_f32 v151, s3, v151
    v_cvt_pk_bf16_f32 v151, v151, v151
    v_lshlrev_b32 v151, 16, v151
    v_cvt_pk_bf16_f32 v152, v152, v152
    v_lshlrev_b32 v152, 16, v152
    v_mul_f32 v152, s3, v152
    v_cvt_pk_bf16_f32 v152, v152, v152
    v_lshlrev_b32 v152, 16, v152
    v_cvt_pk_bf16_f32 v153, v153, v153
    v_lshlrev_b32 v153, 16, v153
    v_mul_f32 v153, s3, v153
    v_cvt_pk_bf16_f32 v153, v153, v153
    v_lshlrev_b32 v153, 16, v153
    v_cvt_pk_bf16_f32 v154, v154, v154
    v_lshlrev_b32 v154, 16, v154
    v_mul_f32 v154, s3, v154
    v_cvt_pk_bf16_f32 v154, v154, v154
    v_lshlrev_b32 v154, 16, v154
    v_cvt_pk_bf16_f32 v155, v155, v155
    v_lshlrev_b32 v155, 16, v155
    v_mul_f32 v155, s3, v155
    v_cvt_pk_bf16_f32 v155, v155, v155
    v_lshlrev_b32 v155, 16, v155
    v_cvt_pk_bf16_f32 v156, v156, v156
    v_lshlrev_b32 v156, 16, v156
    v_mul_f32 v156, s3, v156
    v_cvt_pk_bf16_f32 v156, v156, v156
    v_lshlrev_b32 v156, 16, v156
    v_cvt_pk_bf16_f32 v157, v157, v157
    v_lshlrev_b32 v157, 16, v157
    v_mul_f32 v157, s3, v157
    v_cvt_pk_bf16_f32 v157, v157, v157
    v_lshlrev_b32 v157, 16, v157
    v_cvt_pk_bf16_f32 v158, v158, v158
    v_lshlrev_b32 v158, 16, v158
    v_mul_f32 v158, s3, v158
    v_cvt_pk_bf16_f32 v158, v158, v158
    v_lshlrev_b32 v158, 16, v158
    v_cvt_pk_bf16_f32 v159, v159, v159
    v_lshlrev_b32 v159, 16, v159
    v_mul_f32 v159, s3, v159
    v_cvt_pk_bf16_f32 v159, v159, v159
    v_lshlrev_b32 v159, 16, v159
    v_cvt_pk_bf16_f32 v160, v160, v160
    v_lshlrev_b32 v160, 16, v160
    v_mul_f32 v160, s3, v160
    v_cvt_pk_bf16_f32 v160, v160, v160
    v_lshlrev_b32 v160, 16, v160
    v_cvt_pk_bf16_f32 v161, v161, v161
    v_lshlrev_b32 v161, 16, v161
    v_mul_f32 v161, s3, v161
    v_cvt_pk_bf16_f32 v161, v161, v161
    v_lshlrev_b32 v161, 16, v161
    v_cvt_pk_bf16_f32 v162, v162, v162
    v_lshlrev_b32 v162, 16, v162
    v_mul_f32 v162, s3, v162
    v_cvt_pk_bf16_f32 v162, v162, v162
    v_lshlrev_b32 v162, 16, v162
    v_cvt_pk_bf16_f32 v163, v163, v163
    v_lshlrev_b32 v163, 16, v163
    v_mul_f32 v163, s3, v163
    v_cvt_pk_bf16_f32 v163, v163, v163
    v_lshlrev_b32 v163, 16, v163
    v_cvt_pk_bf16_f32 v164, v164, v164
    v_lshlrev_b32 v164, 16, v164
    v_mul_f32 v164, s3, v164
    v_cvt_pk_bf16_f32 v164, v164, v164
    v_lshlrev_b32 v164, 16, v164
    v_cvt_pk_bf16_f32 v165, v165, v165
    v_lshlrev_b32 v165, 16, v165
    v_mul_f32 v165, s3, v165
    v_cvt_pk_bf16_f32 v165, v165, v165
    v_lshlrev_b32 v165, 16, v165
    v_cvt_pk_bf16_f32 v166, v166, v166
    v_lshlrev_b32 v166, 16, v166
    v_mul_f32 v166, s3, v166
    v_cvt_pk_bf16_f32 v166, v166, v166
    v_lshlrev_b32 v166, 16, v166
    v_cvt_pk_bf16_f32 v167, v167, v167
    v_lshlrev_b32 v167, 16, v167
    v_mul_f32 v167, s3, v167
    v_cvt_pk_bf16_f32 v167, v167, v167
    v_lshlrev_b32 v167, 16, v167
    v_cvt_pk_bf16_f32 v168, v168, v168
    v_lshlrev_b32 v168, 16, v168
    v_mul_f32 v168, s3, v168
    v_cvt_pk_bf16_f32 v168, v168, v168
    v_lshlrev_b32 v168, 16, v168
    v_cvt_pk_bf16_f32 v169, v169, v169
    v_lshlrev_b32 v169, 16, v169
    v_mul_f32 v169, s3, v169
    v_cvt_pk_bf16_f32 v169, v169, v169
    v_lshlrev_b32 v169, 16, v169
    v_cvt_pk_bf16_f32 v170, v170, v170
    v_lshlrev_b32 v170, 16, v170
    v_mul_f32 v170, s3, v170
    v_cvt_pk_bf16_f32 v170, v170, v170
    v_lshlrev_b32 v170, 16, v170
    v_cvt_pk_bf16_f32 v171, v171, v171
    v_lshlrev_b32 v171, 16, v171
    v_mul_f32 v171, s3, v171
    v_cvt_pk_bf16_f32 v171, v171, v171
    v_lshlrev_b32 v171, 16, v171
    v_cvt_pk_bf16_f32 v172, v172, v172
    v_lshlrev_b32 v172, 16, v172
    v_mul_f32 v172, s3, v172
    v_cvt_pk_bf16_f32 v172, v172, v172
    v_lshlrev_b32 v172, 16, v172
    v_cvt_pk_bf16_f32 v173, v173, v173
    v_lshlrev_b32 v173, 16, v173
    v_mul_f32 v173, s3, v173
    v_cvt_pk_bf16_f32 v173, v173, v173
    v_lshlrev_b32 v173, 16, v173
    v_cvt_pk_bf16_f32 v174, v174, v174
    v_lshlrev_b32 v174, 16, v174
    v_mul_f32 v174, s3, v174
    v_cvt_pk_bf16_f32 v174, v174, v174
    v_lshlrev_b32 v174, 16, v174
    v_cvt_pk_bf16_f32 v175, v175, v175
    v_lshlrev_b32 v175, 16, v175
    v_mul_f32 v175, s3, v175
    v_cvt_pk_bf16_f32 v175, v175, v175
    v_lshlrev_b32 v175, 16, v175
    v_cvt_pk_bf16_f32 v176, v176, v176
    v_lshlrev_b32 v176, 16, v176
    v_mul_f32 v176, s3, v176
    v_cvt_pk_bf16_f32 v176, v176, v176
    v_lshlrev_b32 v176, 16, v176
    v_cvt_pk_bf16_f32 v177, v177, v177
    v_lshlrev_b32 v177, 16, v177
    v_mul_f32 v177, s3, v177
    v_cvt_pk_bf16_f32 v177, v177, v177
    v_lshlrev_b32 v177, 16, v177
    v_cvt_pk_bf16_f32 v178, v178, v178
    v_lshlrev_b32 v178, 16, v178
    v_mul_f32 v178, s3, v178
    v_cvt_pk_bf16_f32 v178, v178, v178
    v_lshlrev_b32 v178, 16, v178
    v_cvt_pk_bf16_f32 v179, v179, v179
    v_lshlrev_b32 v179, 16, v179
    v_mul_f32 v179, s3, v179
    v_cvt_pk_bf16_f32 v179, v179, v179
    v_lshlrev_b32 v179, 16, v179
    v_cvt_pk_bf16_f32 v180, v180, v180
    v_lshlrev_b32 v180, 16, v180
    v_mul_f32 v180, s3, v180
    v_cvt_pk_bf16_f32 v180, v180, v180
    v_lshlrev_b32 v180, 16, v180
    v_cvt_pk_bf16_f32 v181, v181, v181
    v_lshlrev_b32 v181, 16, v181
    v_mul_f32 v181, s3, v181
    v_cvt_pk_bf16_f32 v181, v181, v181
    v_lshlrev_b32 v181, 16, v181
    v_cvt_pk_bf16_f32 v182, v182, v182
    v_lshlrev_b32 v182, 16, v182
    v_mul_f32 v182, s3, v182
    v_cvt_pk_bf16_f32 v182, v182, v182
    v_lshlrev_b32 v182, 16, v182
    v_cvt_pk_bf16_f32 v183, v183, v183
    v_lshlrev_b32 v183, 16, v183
    v_mul_f32 v183, s3, v183
    v_cvt_pk_bf16_f32 v183, v183, v183
    v_lshlrev_b32 v183, 16, v183
    v_cvt_pk_bf16_f32 v184, v184, v184
    v_lshlrev_b32 v184, 16, v184
    v_mul_f32 v184, s3, v184
    v_cvt_pk_bf16_f32 v184, v184, v184
    v_lshlrev_b32 v184, 16, v184
    v_cvt_pk_bf16_f32 v185, v185, v185
    v_lshlrev_b32 v185, 16, v185
    v_mul_f32 v185, s3, v185
    v_cvt_pk_bf16_f32 v185, v185, v185
    v_lshlrev_b32 v185, 16, v185
    v_cvt_pk_bf16_f32 v186, v186, v186
    v_lshlrev_b32 v186, 16, v186
    v_mul_f32 v186, s3, v186
    v_cvt_pk_bf16_f32 v186, v186, v186
    v_lshlrev_b32 v186, 16, v186
    v_cvt_pk_bf16_f32 v187, v187, v187
    v_lshlrev_b32 v187, 16, v187
    v_mul_f32 v187, s3, v187
    v_cvt_pk_bf16_f32 v187, v187, v187
    v_lshlrev_b32 v187, 16, v187
    v_cvt_pk_bf16_f32 v188, v188, v188
    v_lshlrev_b32 v188, 16, v188
    v_mul_f32 v188, s3, v188
    v_cvt_pk_bf16_f32 v188, v188, v188
    v_lshlrev_b32 v188, 16, v188
    v_cvt_pk_bf16_f32 v189, v189, v189
    v_lshlrev_b32 v189, 16, v189
    v_mul_f32 v189, s3, v189
    v_cvt_pk_bf16_f32 v189, v189, v189
    v_lshlrev_b32 v189, 16, v189
    v_cvt_pk_bf16_f32 v190, v190, v190
    v_lshlrev_b32 v190, 16, v190
    v_mul_f32 v190, s3, v190
    v_cvt_pk_bf16_f32 v190, v190, v190
    v_lshlrev_b32 v190, 16, v190
    v_cvt_pk_bf16_f32 v191, v191, v191
    v_lshlrev_b32 v191, 16, v191
    v_mul_f32 v191, s3, v191
    v_cvt_pk_bf16_f32 v191, v191, v191
    v_lshlrev_b32 v191, 16, v191
    v_cvt_pk_bf16_f32 v192, v192, v192
    v_lshlrev_b32 v192, 16, v192
    v_mul_f32 v192, s3, v192
    v_cvt_pk_bf16_f32 v192, v192, v192
    v_lshlrev_b32 v192, 16, v192
    v_cvt_pk_bf16_f32 v193, v193, v193
    v_lshlrev_b32 v193, 16, v193
    v_mul_f32 v193, s3, v193
    v_cvt_pk_bf16_f32 v193, v193, v193
    v_lshlrev_b32 v193, 16, v193
    v_cvt_pk_bf16_f32 v194, v194, v194
    v_lshlrev_b32 v194, 16, v194
    v_mul_f32 v194, s3, v194
    v_cvt_pk_bf16_f32 v194, v194, v194
    v_lshlrev_b32 v194, 16, v194
    v_cvt_pk_bf16_f32 v195, v195, v195
    v_lshlrev_b32 v195, 16, v195
    v_mul_f32 v195, s3, v195
    v_cvt_pk_bf16_f32 v195, v195, v195
    v_lshlrev_b32 v195, 16, v195
    v_cvt_pk_bf16_f32 v196, v196, v196
    v_lshlrev_b32 v196, 16, v196
    v_mul_f32 v196, s3, v196
    v_cvt_pk_bf16_f32 v196, v196, v196
    v_lshlrev_b32 v196, 16, v196
    v_cvt_pk_bf16_f32 v197, v197, v197
    v_lshlrev_b32 v197, 16, v197
    v_mul_f32 v197, s3, v197
    v_cvt_pk_bf16_f32 v197, v197, v197
    v_lshlrev_b32 v197, 16, v197
    v_cvt_pk_bf16_f32 v198, v198, v198
    v_lshlrev_b32 v198, 16, v198
    v_mul_f32 v198, s3, v198
    v_cvt_pk_bf16_f32 v198, v198, v198
    v_lshlrev_b32 v198, 16, v198
    v_cvt_pk_bf16_f32 v199, v199, v199
    v_lshlrev_b32 v199, 16, v199
    v_mul_f32 v199, s3, v199
    v_cvt_pk_bf16_f32 v199, v199, v199
    v_lshlrev_b32 v199, 16, v199
    v_cvt_pk_bf16_f32 v200, v200, v200
    v_lshlrev_b32 v200, 16, v200
    v_mul_f32 v200, s3, v200
    v_cvt_pk_bf16_f32 v200, v200, v200
    v_lshlrev_b32 v200, 16, v200
    v_cvt_pk_bf16_f32 v201, v201, v201
    v_lshlrev_b32 v201, 16, v201
    v_mul_f32 v201, s3, v201
    v_cvt_pk_bf16_f32 v201, v201, v201
    v_lshlrev_b32 v201, 16, v201
    v_cvt_pk_bf16_f32 v202, v202, v202
    v_lshlrev_b32 v202, 16, v202
    v_mul_f32 v202, s3, v202
    v_cvt_pk_bf16_f32 v202, v202, v202
    v_lshlrev_b32 v202, 16, v202
    v_cvt_pk_bf16_f32 v203, v203, v203
    v_lshlrev_b32 v203, 16, v203
    v_mul_f32 v203, s3, v203
    v_cvt_pk_bf16_f32 v203, v203, v203
    v_lshlrev_b32 v203, 16, v203
    v_cvt_pk_bf16_f32 v204, v204, v204
    v_lshlrev_b32 v204, 16, v204
    v_mul_f32 v204, s3, v204
    v_cvt_pk_bf16_f32 v204, v204, v204
    v_lshlrev_b32 v204, 16, v204
    v_cvt_pk_bf16_f32 v205, v205, v205
    v_lshlrev_b32 v205, 16, v205
    v_mul_f32 v205, s3, v205
    v_cvt_pk_bf16_f32 v205, v205, v205
    v_lshlrev_b32 v205, 16, v205
    v_cvt_pk_bf16_f32 v206, v206, v206
    v_lshlrev_b32 v206, 16, v206
    v_mul_f32 v206, s3, v206
    v_cvt_pk_bf16_f32 v206, v206, v206
    v_lshlrev_b32 v206, 16, v206
    v_cvt_pk_bf16_f32 v207, v207, v207
    v_lshlrev_b32 v207, 16, v207
    v_mul_f32 v207, s3, v207
    v_cvt_pk_bf16_f32 v207, v207, v207
    v_lshlrev_b32 v207, 16, v207
    v_and_b32 v2, 31, v1
    v_lshrrev_b32 v4, 5, v1
    v_lshlrev_b32 v4, 2, v4
    v_sub_u32 v2, v2, v4
    v_mov_b32 v5, 0xff800000

    v_cmp_gt_i32 vcc, 0, v2
    v_cndmask_b32 v64, v5, v64, vcc
    v_cmp_le_i32 vcc, 0, v2
    v_cndmask_b32 v192, v5, v192, vcc
    v_cmp_gt_i32 vcc, 1, v2
    v_cndmask_b32 v65, v5, v65, vcc
    v_cmp_le_i32 vcc, 1, v2
    v_cndmask_b32 v193, v5, v193, vcc
    v_cmp_gt_i32 vcc, 2, v2
    v_cndmask_b32 v66, v5, v66, vcc
    v_cmp_le_i32 vcc, 2, v2
    v_cndmask_b32 v194, v5, v194, vcc
    v_cmp_gt_i32 vcc, 3, v2
    v_cndmask_b32 v67, v5, v67, vcc
    v_cmp_le_i32 vcc, 3, v2
    v_cndmask_b32 v195, v5, v195, vcc
    v_cmp_gt_i32 vcc, 8, v2
    v_cndmask_b32 v68, v5, v68, vcc
    v_cmp_le_i32 vcc, 8, v2
    v_cndmask_b32 v196, v5, v196, vcc
    v_cmp_gt_i32 vcc, 9, v2
    v_cndmask_b32 v69, v5, v69, vcc
    v_cmp_le_i32 vcc, 9, v2
    v_cndmask_b32 v197, v5, v197, vcc
    v_cmp_gt_i32 vcc, 10, v2
    v_cndmask_b32 v70, v5, v70, vcc
    v_cmp_le_i32 vcc, 10, v2
    v_cndmask_b32 v198, v5, v198, vcc
    v_cmp_gt_i32 vcc, 11, v2
    v_cndmask_b32 v71, v5, v71, vcc
    v_cmp_le_i32 vcc, 11, v2
    v_cndmask_b32 v199, v5, v199, vcc
    v_cmp_gt_i32 vcc, 16, v2
    v_cndmask_b32 v72, v5, v72, vcc
    v_cmp_le_i32 vcc, 16, v2
    v_cndmask_b32 v200, v5, v200, vcc
    v_cmp_gt_i32 vcc, 17, v2
    v_cndmask_b32 v73, v5, v73, vcc
    v_cmp_le_i32 vcc, 17, v2
    v_cndmask_b32 v201, v5, v201, vcc
    v_cmp_gt_i32 vcc, 18, v2
    v_cndmask_b32 v74, v5, v74, vcc
    v_cmp_le_i32 vcc, 18, v2
    v_cndmask_b32 v202, v5, v202, vcc
    v_cmp_gt_i32 vcc, 19, v2
    v_cndmask_b32 v75, v5, v75, vcc
    v_cmp_le_i32 vcc, 19, v2
    v_cndmask_b32 v203, v5, v203, vcc
    v_cmp_gt_i32 vcc, 24, v2
    v_cndmask_b32 v76, v5, v76, vcc
    v_cmp_le_i32 vcc, 24, v2
    v_cndmask_b32 v204, v5, v204, vcc
    v_cmp_gt_i32 vcc, 25, v2
    v_cndmask_b32 v77, v5, v77, vcc
    v_cmp_le_i32 vcc, 25, v2
    v_cndmask_b32 v205, v5, v205, vcc
    v_cmp_gt_i32 vcc, 26, v2
    v_cndmask_b32 v78, v5, v78, vcc
    v_cmp_le_i32 vcc, 26, v2
    v_cndmask_b32 v206, v5, v206, vcc
    v_cmp_gt_i32 vcc, 27, v2
    v_cndmask_b32 v79, v5, v79, vcc
    v_cmp_le_i32 vcc, 27, v2
    v_cndmask_b32 v207, v5, v207, vcc
    v_max_f32 v7, v64, v65
    v_max3_f32 v7, v7, v66, v67
    v_max3_f32 v7, v7, v68, v69
    v_max3_f32 v7, v7, v70, v71
    v_max3_f32 v7, v7, v72, v73
    v_max3_f32 v7, v7, v74, v75
    v_max3_f32 v7, v7, v76, v77
    v_max3_f32 v7, v7, v78, v79
    v_max3_f32 v7, v7, v80, v81
    v_max3_f32 v7, v7, v82, v83
    v_max3_f32 v7, v7, v84, v85
    v_max3_f32 v7, v7, v86, v87
    v_max3_f32 v7, v7, v88, v89
    v_max3_f32 v7, v7, v90, v91
    v_max3_f32 v7, v7, v92, v93
    v_max3_f32 v7, v7, v94, v95
    v_max3_f32 v7, v7, v96, v97
    v_max3_f32 v7, v7, v98, v99
    v_max3_f32 v7, v7, v100, v101
    v_max3_f32 v7, v7, v102, v103
    v_max3_f32 v7, v7, v104, v105
    v_max3_f32 v7, v7, v106, v107
    v_max3_f32 v7, v7, v108, v109
    v_max3_f32 v7, v7, v110, v111
    v_max3_f32 v7, v7, v112, v113
    v_max3_f32 v7, v7, v114, v115
    v_max3_f32 v7, v7, v116, v117
    v_max3_f32 v7, v7, v118, v119
    v_max3_f32 v7, v7, v120, v121
    v_max3_f32 v7, v7, v122, v123
    v_max3_f32 v7, v7, v124, v125
    v_max3_f32 v7, v7, v126, v127
    v_max3_f32 v7, v7, v128, v129
    v_max3_f32 v7, v7, v130, v131
    v_max3_f32 v7, v7, v132, v133
    v_max3_f32 v7, v7, v134, v135
    v_max3_f32 v7, v7, v136, v137
    v_max3_f32 v7, v7, v138, v139
    v_max3_f32 v7, v7, v140, v141
    v_max3_f32 v7, v7, v142, v143
    v_max3_f32 v7, v7, v144, v145
    v_max3_f32 v7, v7, v146, v147
    v_max3_f32 v7, v7, v148, v149
    v_max3_f32 v7, v7, v150, v151
    v_max3_f32 v7, v7, v152, v153
    v_max3_f32 v7, v7, v154, v155
    v_max3_f32 v7, v7, v156, v157
    v_max3_f32 v7, v7, v158, v159
    v_max3_f32 v7, v7, v160, v161
    v_max3_f32 v7, v7, v162, v163
    v_max3_f32 v7, v7, v164, v165
    v_max3_f32 v7, v7, v166, v167
    v_max3_f32 v7, v7, v168, v169
    v_max3_f32 v7, v7, v170, v171
    v_max3_f32 v7, v7, v172, v173
    v_max3_f32 v7, v7, v174, v175
    v_max3_f32 v7, v7, v176, v177
    v_max3_f32 v7, v7, v178, v179
    v_max3_f32 v7, v7, v180, v181
    v_max3_f32 v7, v7, v182, v183
    v_max3_f32 v7, v7, v184, v185
    v_max3_f32 v7, v7, v186, v187
    v_max3_f32 v7, v7, v188, v189
    v_max3_f32 v7, v7, v190, v191
    v_max3_f32 v7, v7, v192, v193
    v_max3_f32 v7, v7, v194, v195
    v_max3_f32 v7, v7, v196, v197
    v_max3_f32 v7, v7, v198, v199
    v_max3_f32 v7, v7, v200, v201
    v_max3_f32 v7, v7, v202, v203
    v_max3_f32 v7, v7, v204, v205
    v_max3_f32 v7, v7, v206, v207
    v_xor_b32 v2, 32, v1
    v_lshlrev_b32 v2, 2, v2
    ds_bpermute_b32 v4, v2, v7
    s_waitcnt lgkmcnt(0)
    v_max_f32 v7, v7, v4
    s_mov_b32 s3, 0x3fb8aa3b
    v_mul_f32 v7, s3, v7
    v_mov_b32 v5, 0

    v_fma_f32 v64, v64, s3, -v7
    v_exp_f32 v64, v64
    s_nop 0
    v_add_f32 v5, v5, v64
    v_fma_f32 v65, v65, s3, -v7
    v_exp_f32 v65, v65
    s_nop 0
    v_add_f32 v5, v5, v65
    v_fma_f32 v66, v66, s3, -v7
    v_exp_f32 v66, v66
    s_nop 0
    v_add_f32 v5, v5, v66
    v_fma_f32 v67, v67, s3, -v7
    v_exp_f32 v67, v67
    s_nop 0
    v_add_f32 v5, v5, v67
    v_fma_f32 v68, v68, s3, -v7
    v_exp_f32 v68, v68
    s_nop 0
    v_add_f32 v5, v5, v68
    v_fma_f32 v69, v69, s3, -v7
    v_exp_f32 v69, v69
    s_nop 0
    v_add_f32 v5, v5, v69
    v_fma_f32 v70, v70, s3, -v7
    v_exp_f32 v70, v70
    s_nop 0
    v_add_f32 v5, v5, v70
    v_fma_f32 v71, v71, s3, -v7
    v_exp_f32 v71, v71
    s_nop 0
    v_add_f32 v5, v5, v71
    v_fma_f32 v72, v72, s3, -v7
    v_exp_f32 v72, v72
    s_nop 0
    v_add_f32 v5, v5, v72
    v_fma_f32 v73, v73, s3, -v7
    v_exp_f32 v73, v73
    s_nop 0
    v_add_f32 v5, v5, v73
    v_fma_f32 v74, v74, s3, -v7
    v_exp_f32 v74, v74
    s_nop 0
    v_add_f32 v5, v5, v74
    v_fma_f32 v75, v75, s3, -v7
    v_exp_f32 v75, v75
    s_nop 0
    v_add_f32 v5, v5, v75
    v_fma_f32 v76, v76, s3, -v7
    v_exp_f32 v76, v76
    s_nop 0
    v_add_f32 v5, v5, v76
    v_fma_f32 v77, v77, s3, -v7
    v_exp_f32 v77, v77
    s_nop 0
    v_add_f32 v5, v5, v77
    v_fma_f32 v78, v78, s3, -v7
    v_exp_f32 v78, v78
    s_nop 0
    v_add_f32 v5, v5, v78
    v_fma_f32 v79, v79, s3, -v7
    v_exp_f32 v79, v79
    s_nop 0
    v_add_f32 v5, v5, v79
    v_fma_f32 v80, v80, s3, -v7
    v_exp_f32 v80, v80
    s_nop 0
    v_add_f32 v5, v5, v80
    v_fma_f32 v81, v81, s3, -v7
    v_exp_f32 v81, v81
    s_nop 0
    v_add_f32 v5, v5, v81
    v_fma_f32 v82, v82, s3, -v7
    v_exp_f32 v82, v82
    s_nop 0
    v_add_f32 v5, v5, v82
    v_fma_f32 v83, v83, s3, -v7
    v_exp_f32 v83, v83
    s_nop 0
    v_add_f32 v5, v5, v83
    v_fma_f32 v84, v84, s3, -v7
    v_exp_f32 v84, v84
    s_nop 0
    v_add_f32 v5, v5, v84
    v_fma_f32 v85, v85, s3, -v7
    v_exp_f32 v85, v85
    s_nop 0
    v_add_f32 v5, v5, v85
    v_fma_f32 v86, v86, s3, -v7
    v_exp_f32 v86, v86
    s_nop 0
    v_add_f32 v5, v5, v86
    v_fma_f32 v87, v87, s3, -v7
    v_exp_f32 v87, v87
    s_nop 0
    v_add_f32 v5, v5, v87
    v_fma_f32 v88, v88, s3, -v7
    v_exp_f32 v88, v88
    s_nop 0
    v_add_f32 v5, v5, v88
    v_fma_f32 v89, v89, s3, -v7
    v_exp_f32 v89, v89
    s_nop 0
    v_add_f32 v5, v5, v89
    v_fma_f32 v90, v90, s3, -v7
    v_exp_f32 v90, v90
    s_nop 0
    v_add_f32 v5, v5, v90
    v_fma_f32 v91, v91, s3, -v7
    v_exp_f32 v91, v91
    s_nop 0
    v_add_f32 v5, v5, v91
    v_fma_f32 v92, v92, s3, -v7
    v_exp_f32 v92, v92
    s_nop 0
    v_add_f32 v5, v5, v92
    v_fma_f32 v93, v93, s3, -v7
    v_exp_f32 v93, v93
    s_nop 0
    v_add_f32 v5, v5, v93
    v_fma_f32 v94, v94, s3, -v7
    v_exp_f32 v94, v94
    s_nop 0
    v_add_f32 v5, v5, v94
    v_fma_f32 v95, v95, s3, -v7
    v_exp_f32 v95, v95
    s_nop 0
    v_add_f32 v5, v5, v95
    v_fma_f32 v96, v96, s3, -v7
    v_exp_f32 v96, v96
    s_nop 0
    v_add_f32 v5, v5, v96
    v_fma_f32 v97, v97, s3, -v7
    v_exp_f32 v97, v97
    s_nop 0
    v_add_f32 v5, v5, v97
    v_fma_f32 v98, v98, s3, -v7
    v_exp_f32 v98, v98
    s_nop 0
    v_add_f32 v5, v5, v98
    v_fma_f32 v99, v99, s3, -v7
    v_exp_f32 v99, v99
    s_nop 0
    v_add_f32 v5, v5, v99
    v_fma_f32 v100, v100, s3, -v7
    v_exp_f32 v100, v100
    s_nop 0
    v_add_f32 v5, v5, v100
    v_fma_f32 v101, v101, s3, -v7
    v_exp_f32 v101, v101
    s_nop 0
    v_add_f32 v5, v5, v101
    v_fma_f32 v102, v102, s3, -v7
    v_exp_f32 v102, v102
    s_nop 0
    v_add_f32 v5, v5, v102
    v_fma_f32 v103, v103, s3, -v7
    v_exp_f32 v103, v103
    s_nop 0
    v_add_f32 v5, v5, v103
    v_fma_f32 v104, v104, s3, -v7
    v_exp_f32 v104, v104
    s_nop 0
    v_add_f32 v5, v5, v104
    v_fma_f32 v105, v105, s3, -v7
    v_exp_f32 v105, v105
    s_nop 0
    v_add_f32 v5, v5, v105
    v_fma_f32 v106, v106, s3, -v7
    v_exp_f32 v106, v106
    s_nop 0
    v_add_f32 v5, v5, v106
    v_fma_f32 v107, v107, s3, -v7
    v_exp_f32 v107, v107
    s_nop 0
    v_add_f32 v5, v5, v107
    v_fma_f32 v108, v108, s3, -v7
    v_exp_f32 v108, v108
    s_nop 0
    v_add_f32 v5, v5, v108
    v_fma_f32 v109, v109, s3, -v7
    v_exp_f32 v109, v109
    s_nop 0
    v_add_f32 v5, v5, v109
    v_fma_f32 v110, v110, s3, -v7
    v_exp_f32 v110, v110
    s_nop 0
    v_add_f32 v5, v5, v110
    v_fma_f32 v111, v111, s3, -v7
    v_exp_f32 v111, v111
    s_nop 0
    v_add_f32 v5, v5, v111
    v_fma_f32 v112, v112, s3, -v7
    v_exp_f32 v112, v112
    s_nop 0
    v_add_f32 v5, v5, v112
    v_fma_f32 v113, v113, s3, -v7
    v_exp_f32 v113, v113
    s_nop 0
    v_add_f32 v5, v5, v113
    v_fma_f32 v114, v114, s3, -v7
    v_exp_f32 v114, v114
    s_nop 0
    v_add_f32 v5, v5, v114
    v_fma_f32 v115, v115, s3, -v7
    v_exp_f32 v115, v115
    s_nop 0
    v_add_f32 v5, v5, v115
    v_fma_f32 v116, v116, s3, -v7
    v_exp_f32 v116, v116
    s_nop 0
    v_add_f32 v5, v5, v116
    v_fma_f32 v117, v117, s3, -v7
    v_exp_f32 v117, v117
    s_nop 0
    v_add_f32 v5, v5, v117
    v_fma_f32 v118, v118, s3, -v7
    v_exp_f32 v118, v118
    s_nop 0
    v_add_f32 v5, v5, v118
    v_fma_f32 v119, v119, s3, -v7
    v_exp_f32 v119, v119
    s_nop 0
    v_add_f32 v5, v5, v119
    v_fma_f32 v120, v120, s3, -v7
    v_exp_f32 v120, v120
    s_nop 0
    v_add_f32 v5, v5, v120
    v_fma_f32 v121, v121, s3, -v7
    v_exp_f32 v121, v121
    s_nop 0
    v_add_f32 v5, v5, v121
    v_fma_f32 v122, v122, s3, -v7
    v_exp_f32 v122, v122
    s_nop 0
    v_add_f32 v5, v5, v122
    v_fma_f32 v123, v123, s3, -v7
    v_exp_f32 v123, v123
    s_nop 0
    v_add_f32 v5, v5, v123
    v_fma_f32 v124, v124, s3, -v7
    v_exp_f32 v124, v124
    s_nop 0
    v_add_f32 v5, v5, v124
    v_fma_f32 v125, v125, s3, -v7
    v_exp_f32 v125, v125
    s_nop 0
    v_add_f32 v5, v5, v125
    v_fma_f32 v126, v126, s3, -v7
    v_exp_f32 v126, v126
    s_nop 0
    v_add_f32 v5, v5, v126
    v_fma_f32 v127, v127, s3, -v7
    v_exp_f32 v127, v127
    s_nop 0
    v_add_f32 v5, v5, v127
    v_fma_f32 v128, v128, s3, -v7
    v_exp_f32 v128, v128
    s_nop 0
    v_add_f32 v5, v5, v128
    v_fma_f32 v129, v129, s3, -v7
    v_exp_f32 v129, v129
    s_nop 0
    v_add_f32 v5, v5, v129
    v_fma_f32 v130, v130, s3, -v7
    v_exp_f32 v130, v130
    s_nop 0
    v_add_f32 v5, v5, v130
    v_fma_f32 v131, v131, s3, -v7
    v_exp_f32 v131, v131
    s_nop 0
    v_add_f32 v5, v5, v131
    v_fma_f32 v132, v132, s3, -v7
    v_exp_f32 v132, v132
    s_nop 0
    v_add_f32 v5, v5, v132
    v_fma_f32 v133, v133, s3, -v7
    v_exp_f32 v133, v133
    s_nop 0
    v_add_f32 v5, v5, v133
    v_fma_f32 v134, v134, s3, -v7
    v_exp_f32 v134, v134
    s_nop 0
    v_add_f32 v5, v5, v134
    v_fma_f32 v135, v135, s3, -v7
    v_exp_f32 v135, v135
    s_nop 0
    v_add_f32 v5, v5, v135
    v_fma_f32 v136, v136, s3, -v7
    v_exp_f32 v136, v136
    s_nop 0
    v_add_f32 v5, v5, v136
    v_fma_f32 v137, v137, s3, -v7
    v_exp_f32 v137, v137
    s_nop 0
    v_add_f32 v5, v5, v137
    v_fma_f32 v138, v138, s3, -v7
    v_exp_f32 v138, v138
    s_nop 0
    v_add_f32 v5, v5, v138
    v_fma_f32 v139, v139, s3, -v7
    v_exp_f32 v139, v139
    s_nop 0
    v_add_f32 v5, v5, v139
    v_fma_f32 v140, v140, s3, -v7
    v_exp_f32 v140, v140
    s_nop 0
    v_add_f32 v5, v5, v140
    v_fma_f32 v141, v141, s3, -v7
    v_exp_f32 v141, v141
    s_nop 0
    v_add_f32 v5, v5, v141
    v_fma_f32 v142, v142, s3, -v7
    v_exp_f32 v142, v142
    s_nop 0
    v_add_f32 v5, v5, v142
    v_fma_f32 v143, v143, s3, -v7
    v_exp_f32 v143, v143
    s_nop 0
    v_add_f32 v5, v5, v143
    v_fma_f32 v144, v144, s3, -v7
    v_exp_f32 v144, v144
    s_nop 0
    v_add_f32 v5, v5, v144
    v_fma_f32 v145, v145, s3, -v7
    v_exp_f32 v145, v145
    s_nop 0
    v_add_f32 v5, v5, v145
    v_fma_f32 v146, v146, s3, -v7
    v_exp_f32 v146, v146
    s_nop 0
    v_add_f32 v5, v5, v146
    v_fma_f32 v147, v147, s3, -v7
    v_exp_f32 v147, v147
    s_nop 0
    v_add_f32 v5, v5, v147
    v_fma_f32 v148, v148, s3, -v7
    v_exp_f32 v148, v148
    s_nop 0
    v_add_f32 v5, v5, v148
    v_fma_f32 v149, v149, s3, -v7
    v_exp_f32 v149, v149
    s_nop 0
    v_add_f32 v5, v5, v149
    v_fma_f32 v150, v150, s3, -v7
    v_exp_f32 v150, v150
    s_nop 0
    v_add_f32 v5, v5, v150
    v_fma_f32 v151, v151, s3, -v7
    v_exp_f32 v151, v151
    s_nop 0
    v_add_f32 v5, v5, v151
    v_fma_f32 v152, v152, s3, -v7
    v_exp_f32 v152, v152
    s_nop 0
    v_add_f32 v5, v5, v152
    v_fma_f32 v153, v153, s3, -v7
    v_exp_f32 v153, v153
    s_nop 0
    v_add_f32 v5, v5, v153
    v_fma_f32 v154, v154, s3, -v7
    v_exp_f32 v154, v154
    s_nop 0
    v_add_f32 v5, v5, v154
    v_fma_f32 v155, v155, s3, -v7
    v_exp_f32 v155, v155
    s_nop 0
    v_add_f32 v5, v5, v155
    v_fma_f32 v156, v156, s3, -v7
    v_exp_f32 v156, v156
    s_nop 0
    v_add_f32 v5, v5, v156
    v_fma_f32 v157, v157, s3, -v7
    v_exp_f32 v157, v157
    s_nop 0
    v_add_f32 v5, v5, v157
    v_fma_f32 v158, v158, s3, -v7
    v_exp_f32 v158, v158
    s_nop 0
    v_add_f32 v5, v5, v158
    v_fma_f32 v159, v159, s3, -v7
    v_exp_f32 v159, v159
    s_nop 0
    v_add_f32 v5, v5, v159
    v_fma_f32 v160, v160, s3, -v7
    v_exp_f32 v160, v160
    s_nop 0
    v_add_f32 v5, v5, v160
    v_fma_f32 v161, v161, s3, -v7
    v_exp_f32 v161, v161
    s_nop 0
    v_add_f32 v5, v5, v161
    v_fma_f32 v162, v162, s3, -v7
    v_exp_f32 v162, v162
    s_nop 0
    v_add_f32 v5, v5, v162
    v_fma_f32 v163, v163, s3, -v7
    v_exp_f32 v163, v163
    s_nop 0
    v_add_f32 v5, v5, v163
    v_fma_f32 v164, v164, s3, -v7
    v_exp_f32 v164, v164
    s_nop 0
    v_add_f32 v5, v5, v164
    v_fma_f32 v165, v165, s3, -v7
    v_exp_f32 v165, v165
    s_nop 0
    v_add_f32 v5, v5, v165
    v_fma_f32 v166, v166, s3, -v7
    v_exp_f32 v166, v166
    s_nop 0
    v_add_f32 v5, v5, v166
    v_fma_f32 v167, v167, s3, -v7
    v_exp_f32 v167, v167
    s_nop 0
    v_add_f32 v5, v5, v167
    v_fma_f32 v168, v168, s3, -v7
    v_exp_f32 v168, v168
    s_nop 0
    v_add_f32 v5, v5, v168
    v_fma_f32 v169, v169, s3, -v7
    v_exp_f32 v169, v169
    s_nop 0
    v_add_f32 v5, v5, v169
    v_fma_f32 v170, v170, s3, -v7
    v_exp_f32 v170, v170
    s_nop 0
    v_add_f32 v5, v5, v170
    v_fma_f32 v171, v171, s3, -v7
    v_exp_f32 v171, v171
    s_nop 0
    v_add_f32 v5, v5, v171
    v_fma_f32 v172, v172, s3, -v7
    v_exp_f32 v172, v172
    s_nop 0
    v_add_f32 v5, v5, v172
    v_fma_f32 v173, v173, s3, -v7
    v_exp_f32 v173, v173
    s_nop 0
    v_add_f32 v5, v5, v173
    v_fma_f32 v174, v174, s3, -v7
    v_exp_f32 v174, v174
    s_nop 0
    v_add_f32 v5, v5, v174
    v_fma_f32 v175, v175, s3, -v7
    v_exp_f32 v175, v175
    s_nop 0
    v_add_f32 v5, v5, v175
    v_fma_f32 v176, v176, s3, -v7
    v_exp_f32 v176, v176
    s_nop 0
    v_add_f32 v5, v5, v176
    v_fma_f32 v177, v177, s3, -v7
    v_exp_f32 v177, v177
    s_nop 0
    v_add_f32 v5, v5, v177
    v_fma_f32 v178, v178, s3, -v7
    v_exp_f32 v178, v178
    s_nop 0
    v_add_f32 v5, v5, v178
    v_fma_f32 v179, v179, s3, -v7
    v_exp_f32 v179, v179
    s_nop 0
    v_add_f32 v5, v5, v179
    v_fma_f32 v180, v180, s3, -v7
    v_exp_f32 v180, v180
    s_nop 0
    v_add_f32 v5, v5, v180
    v_fma_f32 v181, v181, s3, -v7
    v_exp_f32 v181, v181
    s_nop 0
    v_add_f32 v5, v5, v181
    v_fma_f32 v182, v182, s3, -v7
    v_exp_f32 v182, v182
    s_nop 0
    v_add_f32 v5, v5, v182
    v_fma_f32 v183, v183, s3, -v7
    v_exp_f32 v183, v183
    s_nop 0
    v_add_f32 v5, v5, v183
    v_fma_f32 v184, v184, s3, -v7
    v_exp_f32 v184, v184
    s_nop 0
    v_add_f32 v5, v5, v184
    v_fma_f32 v185, v185, s3, -v7
    v_exp_f32 v185, v185
    s_nop 0
    v_add_f32 v5, v5, v185
    v_fma_f32 v186, v186, s3, -v7
    v_exp_f32 v186, v186
    s_nop 0
    v_add_f32 v5, v5, v186
    v_fma_f32 v187, v187, s3, -v7
    v_exp_f32 v187, v187
    s_nop 0
    v_add_f32 v5, v5, v187
    v_fma_f32 v188, v188, s3, -v7
    v_exp_f32 v188, v188
    s_nop 0
    v_add_f32 v5, v5, v188
    v_fma_f32 v189, v189, s3, -v7
    v_exp_f32 v189, v189
    s_nop 0
    v_add_f32 v5, v5, v189
    v_fma_f32 v190, v190, s3, -v7
    v_exp_f32 v190, v190
    s_nop 0
    v_add_f32 v5, v5, v190
    v_fma_f32 v191, v191, s3, -v7
    v_exp_f32 v191, v191
    s_nop 0
    v_add_f32 v5, v5, v191
    v_fma_f32 v192, v192, s3, -v7
    v_exp_f32 v192, v192
    s_nop 0
    v_add_f32 v5, v5, v192
    v_fma_f32 v193, v193, s3, -v7
    v_exp_f32 v193, v193
    s_nop 0
    v_add_f32 v5, v5, v193
    v_fma_f32 v194, v194, s3, -v7
    v_exp_f32 v194, v194
    s_nop 0
    v_add_f32 v5, v5, v194
    v_fma_f32 v195, v195, s3, -v7
    v_exp_f32 v195, v195
    s_nop 0
    v_add_f32 v5, v5, v195
    v_fma_f32 v196, v196, s3, -v7
    v_exp_f32 v196, v196
    s_nop 0
    v_add_f32 v5, v5, v196
    v_fma_f32 v197, v197, s3, -v7
    v_exp_f32 v197, v197
    s_nop 0
    v_add_f32 v5, v5, v197
    v_fma_f32 v198, v198, s3, -v7
    v_exp_f32 v198, v198
    s_nop 0
    v_add_f32 v5, v5, v198
    v_fma_f32 v199, v199, s3, -v7
    v_exp_f32 v199, v199
    s_nop 0
    v_add_f32 v5, v5, v199
    v_fma_f32 v200, v200, s3, -v7
    v_exp_f32 v200, v200
    s_nop 0
    v_add_f32 v5, v5, v200
    v_fma_f32 v201, v201, s3, -v7
    v_exp_f32 v201, v201
    s_nop 0
    v_add_f32 v5, v5, v201
    v_fma_f32 v202, v202, s3, -v7
    v_exp_f32 v202, v202
    s_nop 0
    v_add_f32 v5, v5, v202
    v_fma_f32 v203, v203, s3, -v7
    v_exp_f32 v203, v203
    s_nop 0
    v_add_f32 v5, v5, v203
    v_fma_f32 v204, v204, s3, -v7
    v_exp_f32 v204, v204
    s_nop 0
    v_add_f32 v5, v5, v204
    v_fma_f32 v205, v205, s3, -v7
    v_exp_f32 v205, v205
    s_nop 0
    v_add_f32 v5, v5, v205
    v_fma_f32 v206, v206, s3, -v7
    v_exp_f32 v206, v206
    s_nop 0
    v_add_f32 v5, v5, v206
    v_fma_f32 v207, v207, s3, -v7
    v_exp_f32 v207, v207
    s_nop 0
    v_add_f32 v5, v5, v207
    ds_bpermute_b32 v4, v2, v5
    s_waitcnt lgkmcnt(0)
    v_add_f32 v5, v5, v4
    v_rcp_f32 v5, v5
    s_nop 0

    v_mul_f32 v64, v64, v5
    v_mul_f32 v65, v65, v5
    v_cvt_pk_bf16_f32 v64, v64, v65
    v_mul_f32 v66, v66, v5
    v_mul_f32 v67, v67, v5
    v_cvt_pk_bf16_f32 v65, v66, v67
    v_mul_f32 v68, v68, v5
    v_mul_f32 v69, v69, v5
    v_cvt_pk_bf16_f32 v66, v68, v69
    v_mul_f32 v70, v70, v5
    v_mul_f32 v71, v71, v5
    v_cvt_pk_bf16_f32 v67, v70, v71
    v_mul_f32 v72, v72, v5
    v_mul_f32 v73, v73, v5
    v_cvt_pk_bf16_f32 v68, v72, v73
    v_mul_f32 v74, v74, v5
    v_mul_f32 v75, v75, v5
    v_cvt_pk_bf16_f32 v69, v74, v75
    v_mul_f32 v76, v76, v5
    v_mul_f32 v77, v77, v5
    v_cvt_pk_bf16_f32 v70, v76, v77
    v_mul_f32 v78, v78, v5
    v_mul_f32 v79, v79, v5
    v_cvt_pk_bf16_f32 v71, v78, v79
    v_mul_f32 v80, v80, v5
    v_mul_f32 v81, v81, v5
    v_cvt_pk_bf16_f32 v72, v80, v81
    v_mul_f32 v82, v82, v5
    v_mul_f32 v83, v83, v5
    v_cvt_pk_bf16_f32 v73, v82, v83
    v_mul_f32 v84, v84, v5
    v_mul_f32 v85, v85, v5
    v_cvt_pk_bf16_f32 v74, v84, v85
    v_mul_f32 v86, v86, v5
    v_mul_f32 v87, v87, v5
    v_cvt_pk_bf16_f32 v75, v86, v87
    v_mul_f32 v88, v88, v5
    v_mul_f32 v89, v89, v5
    v_cvt_pk_bf16_f32 v76, v88, v89
    v_mul_f32 v90, v90, v5
    v_mul_f32 v91, v91, v5
    v_cvt_pk_bf16_f32 v77, v90, v91
    v_mul_f32 v92, v92, v5
    v_mul_f32 v93, v93, v5
    v_cvt_pk_bf16_f32 v78, v92, v93
    v_mul_f32 v94, v94, v5
    v_mul_f32 v95, v95, v5
    v_cvt_pk_bf16_f32 v79, v94, v95
    v_mul_f32 v96, v96, v5
    v_mul_f32 v97, v97, v5
    v_cvt_pk_bf16_f32 v80, v96, v97
    v_mul_f32 v98, v98, v5
    v_mul_f32 v99, v99, v5
    v_cvt_pk_bf16_f32 v81, v98, v99
    v_mul_f32 v100, v100, v5
    v_mul_f32 v101, v101, v5
    v_cvt_pk_bf16_f32 v82, v100, v101
    v_mul_f32 v102, v102, v5
    v_mul_f32 v103, v103, v5
    v_cvt_pk_bf16_f32 v83, v102, v103
    v_mul_f32 v104, v104, v5
    v_mul_f32 v105, v105, v5
    v_cvt_pk_bf16_f32 v84, v104, v105
    v_mul_f32 v106, v106, v5
    v_mul_f32 v107, v107, v5
    v_cvt_pk_bf16_f32 v85, v106, v107
    v_mul_f32 v108, v108, v5
    v_mul_f32 v109, v109, v5
    v_cvt_pk_bf16_f32 v86, v108, v109
    v_mul_f32 v110, v110, v5
    v_mul_f32 v111, v111, v5
    v_cvt_pk_bf16_f32 v87, v110, v111
    v_mul_f32 v112, v112, v5
    v_mul_f32 v113, v113, v5
    v_cvt_pk_bf16_f32 v88, v112, v113
    v_mul_f32 v114, v114, v5
    v_mul_f32 v115, v115, v5
    v_cvt_pk_bf16_f32 v89, v114, v115
    v_mul_f32 v116, v116, v5
    v_mul_f32 v117, v117, v5
    v_cvt_pk_bf16_f32 v90, v116, v117
    v_mul_f32 v118, v118, v5
    v_mul_f32 v119, v119, v5
    v_cvt_pk_bf16_f32 v91, v118, v119
    v_mul_f32 v120, v120, v5
    v_mul_f32 v121, v121, v5
    v_cvt_pk_bf16_f32 v92, v120, v121
    v_mul_f32 v122, v122, v5
    v_mul_f32 v123, v123, v5
    v_cvt_pk_bf16_f32 v93, v122, v123
    v_mul_f32 v124, v124, v5
    v_mul_f32 v125, v125, v5
    v_cvt_pk_bf16_f32 v94, v124, v125
    v_mul_f32 v126, v126, v5
    v_mul_f32 v127, v127, v5
    v_cvt_pk_bf16_f32 v95, v126, v127
    v_mul_f32 v128, v128, v5
    v_mul_f32 v129, v129, v5
    v_cvt_pk_bf16_f32 v96, v128, v129
    v_mul_f32 v130, v130, v5
    v_mul_f32 v131, v131, v5
    v_cvt_pk_bf16_f32 v97, v130, v131
    v_mul_f32 v132, v132, v5
    v_mul_f32 v133, v133, v5
    v_cvt_pk_bf16_f32 v98, v132, v133
    v_mul_f32 v134, v134, v5
    v_mul_f32 v135, v135, v5
    v_cvt_pk_bf16_f32 v99, v134, v135
    v_mul_f32 v136, v136, v5
    v_mul_f32 v137, v137, v5
    v_cvt_pk_bf16_f32 v100, v136, v137
    v_mul_f32 v138, v138, v5
    v_mul_f32 v139, v139, v5
    v_cvt_pk_bf16_f32 v101, v138, v139
    v_mul_f32 v140, v140, v5
    v_mul_f32 v141, v141, v5
    v_cvt_pk_bf16_f32 v102, v140, v141
    v_mul_f32 v142, v142, v5
    v_mul_f32 v143, v143, v5
    v_cvt_pk_bf16_f32 v103, v142, v143
    v_mul_f32 v144, v144, v5
    v_mul_f32 v145, v145, v5
    v_cvt_pk_bf16_f32 v104, v144, v145
    v_mul_f32 v146, v146, v5
    v_mul_f32 v147, v147, v5
    v_cvt_pk_bf16_f32 v105, v146, v147
    v_mul_f32 v148, v148, v5
    v_mul_f32 v149, v149, v5
    v_cvt_pk_bf16_f32 v106, v148, v149
    v_mul_f32 v150, v150, v5
    v_mul_f32 v151, v151, v5
    v_cvt_pk_bf16_f32 v107, v150, v151
    v_mul_f32 v152, v152, v5
    v_mul_f32 v153, v153, v5
    v_cvt_pk_bf16_f32 v108, v152, v153
    v_mul_f32 v154, v154, v5
    v_mul_f32 v155, v155, v5
    v_cvt_pk_bf16_f32 v109, v154, v155
    v_mul_f32 v156, v156, v5
    v_mul_f32 v157, v157, v5
    v_cvt_pk_bf16_f32 v110, v156, v157
    v_mul_f32 v158, v158, v5
    v_mul_f32 v159, v159, v5
    v_cvt_pk_bf16_f32 v111, v158, v159
    v_mul_f32 v160, v160, v5
    v_mul_f32 v161, v161, v5
    v_cvt_pk_bf16_f32 v112, v160, v161
    v_mul_f32 v162, v162, v5
    v_mul_f32 v163, v163, v5
    v_cvt_pk_bf16_f32 v113, v162, v163
    v_mul_f32 v164, v164, v5
    v_mul_f32 v165, v165, v5
    v_cvt_pk_bf16_f32 v114, v164, v165
    v_mul_f32 v166, v166, v5
    v_mul_f32 v167, v167, v5
    v_cvt_pk_bf16_f32 v115, v166, v167
    v_mul_f32 v168, v168, v5
    v_mul_f32 v169, v169, v5
    v_cvt_pk_bf16_f32 v116, v168, v169
    v_mul_f32 v170, v170, v5
    v_mul_f32 v171, v171, v5
    v_cvt_pk_bf16_f32 v117, v170, v171
    v_mul_f32 v172, v172, v5
    v_mul_f32 v173, v173, v5
    v_cvt_pk_bf16_f32 v118, v172, v173
    v_mul_f32 v174, v174, v5
    v_mul_f32 v175, v175, v5
    v_cvt_pk_bf16_f32 v119, v174, v175
    v_mul_f32 v176, v176, v5
    v_mul_f32 v177, v177, v5
    v_cvt_pk_bf16_f32 v120, v176, v177
    v_mul_f32 v178, v178, v5
    v_mul_f32 v179, v179, v5
    v_cvt_pk_bf16_f32 v121, v178, v179
    v_mul_f32 v180, v180, v5
    v_mul_f32 v181, v181, v5
    v_cvt_pk_bf16_f32 v122, v180, v181
    v_mul_f32 v182, v182, v5
    v_mul_f32 v183, v183, v5
    v_cvt_pk_bf16_f32 v123, v182, v183
    v_mul_f32 v184, v184, v5
    v_mul_f32 v185, v185, v5
    v_cvt_pk_bf16_f32 v124, v184, v185
    v_mul_f32 v186, v186, v5
    v_mul_f32 v187, v187, v5
    v_cvt_pk_bf16_f32 v125, v186, v187
    v_mul_f32 v188, v188, v5
    v_mul_f32 v189, v189, v5
    v_cvt_pk_bf16_f32 v126, v188, v189
    v_mul_f32 v190, v190, v5
    v_mul_f32 v191, v191, v5
    v_cvt_pk_bf16_f32 v127, v190, v191
    v_mul_f32 v192, v192, v5
    v_mul_f32 v193, v193, v5
    v_cvt_pk_bf16_f32 v128, v192, v193
    v_mul_f32 v194, v194, v5
    v_mul_f32 v195, v195, v5
    v_cvt_pk_bf16_f32 v129, v194, v195
    v_mul_f32 v196, v196, v5
    v_mul_f32 v197, v197, v5
    v_cvt_pk_bf16_f32 v130, v196, v197
    v_mul_f32 v198, v198, v5
    v_mul_f32 v199, v199, v5
    v_cvt_pk_bf16_f32 v131, v198, v199
    v_mul_f32 v200, v200, v5
    v_mul_f32 v201, v201, v5
    v_cvt_pk_bf16_f32 v132, v200, v201
    v_mul_f32 v202, v202, v5
    v_mul_f32 v203, v203, v5
    v_cvt_pk_bf16_f32 v133, v202, v203
    v_mul_f32 v204, v204, v5
    v_mul_f32 v205, v205, v5
    v_cvt_pk_bf16_f32 v134, v204, v205
    v_mul_f32 v206, v206, v5
    v_mul_f32 v207, v207, v5
    v_cvt_pk_bf16_f32 v135, v206, v207
    v_lshrrev_b32 v2, 5, v1
    v_lshlrev_b32 v2, 2, v2
    v_bfe_u32 v4, v1, 2, 2
    v_add_u32 v2, v2, v4
    v_lshlrev_b32 v6, 6, v2
    v_bfe_u32 v4, v1, 4, 1
    v_lshlrev_b32 v4, 5, v4
    v_add_u32 v6, v6, v4
    v_and_b32 v4, 3, v1
    v_lshlrev_b32 v4, 3, v4
    v_add_u32 v6, v6, v4
    v_add_u32 v6, s33, v6

    v_mov_b32 v208, 0
    v_mov_b32 v209, 0
    v_mov_b32 v210, 0
    v_mov_b32 v211, 0
    v_mov_b32 v212, 0
    v_mov_b32 v213, 0
    v_mov_b32 v214, 0
    v_mov_b32 v215, 0
    v_mov_b32 v216, 0
    v_mov_b32 v217, 0
    v_mov_b32 v218, 0
    v_mov_b32 v219, 0
    v_mov_b32 v220, 0
    v_mov_b32 v221, 0
    v_mov_b32 v222, 0
    v_mov_b32 v223, 0
    s_add_u32 s5, s37, 0
    s_cmp_lt_u32 s5, 256
    s_cbranch_scc1 aa_pk_59

    ds_read_b64_tr_b16 v[16:17], v6 offset:0
    ds_read_b64_tr_b16 v[18:19], v6 offset:512
    ds_read_b64_tr_b16 v[20:21], v6 offset:1024
    ds_read_b64_tr_b16 v[22:23], v6 offset:1536
    s_waitcnt lgkmcnt(0)
    v_mfma_f32_32x32x16_bf16 v[208:223], v[16:19], v[64:67], v[208:223]
    v_mfma_f32_32x32x16_bf16 v[208:223], v[20:23], v[68:71], v[208:223]
    s_nop 7
aa_pk_59:
    s_add_u32 s5, s37, 32
    s_cmp_lt_u32 s5, 256
    s_cbranch_scc1 aa_pk_60

    ds_read_b64_tr_b16 v[16:17], v6 offset:2048
    ds_read_b64_tr_b16 v[18:19], v6 offset:2560
    ds_read_b64_tr_b16 v[20:21], v6 offset:3072
    ds_read_b64_tr_b16 v[22:23], v6 offset:3584
    s_waitcnt lgkmcnt(0)
    v_mfma_f32_32x32x16_bf16 v[208:223], v[16:19], v[72:75], v[208:223]
    v_mfma_f32_32x32x16_bf16 v[208:223], v[20:23], v[76:79], v[208:223]
    s_nop 7
aa_pk_60:
    s_add_u32 s5, s37, 64
    s_cmp_lt_u32 s5, 256
    s_cbranch_scc1 aa_pk_61

    ds_read_b64_tr_b16 v[16:17], v6 offset:4096
    ds_read_b64_tr_b16 v[18:19], v6 offset:4608
    ds_read_b64_tr_b16 v[20:21], v6 offset:5120
    ds_read_b64_tr_b16 v[22:23], v6 offset:5632
    s_waitcnt lgkmcnt(0)
    v_mfma_f32_32x32x16_bf16 v[208:223], v[16:19], v[80:83], v[208:223]
    v_mfma_f32_32x32x16_bf16 v[208:223], v[20:23], v[84:87], v[208:223]
    s_nop 7
aa_pk_61:
    s_add_u32 s5, s37, 96
    s_cmp_lt_u32 s5, 256
    s_cbranch_scc1 aa_pk_62

    ds_read_b64_tr_b16 v[16:17], v6 offset:6144
    ds_read_b64_tr_b16 v[18:19], v6 offset:6656
    ds_read_b64_tr_b16 v[20:21], v6 offset:7168
    ds_read_b64_tr_b16 v[22:23], v6 offset:7680
    s_waitcnt lgkmcnt(0)
    v_mfma_f32_32x32x16_bf16 v[208:223], v[16:19], v[88:91], v[208:223]
    v_mfma_f32_32x32x16_bf16 v[208:223], v[20:23], v[92:95], v[208:223]
    s_nop 7
aa_pk_62:
    s_add_u32 s5, s37, 128
    s_cmp_lt_u32 s5, 256
    s_cbranch_scc1 aa_pk_63

    ds_read_b64_tr_b16 v[16:17], v6 offset:8192
    ds_read_b64_tr_b16 v[18:19], v6 offset:8704
    ds_read_b64_tr_b16 v[20:21], v6 offset:9216
    ds_read_b64_tr_b16 v[22:23], v6 offset:9728
    s_waitcnt lgkmcnt(0)
    v_mfma_f32_32x32x16_bf16 v[208:223], v[16:19], v[96:99], v[208:223]
    v_mfma_f32_32x32x16_bf16 v[208:223], v[20:23], v[100:103], v[208:223]
    s_nop 7
aa_pk_63:
    s_add_u32 s5, s37, 160
    s_cmp_lt_u32 s5, 256
    s_cbranch_scc1 aa_pk_64

    ds_read_b64_tr_b16 v[16:17], v6 offset:10240
    ds_read_b64_tr_b16 v[18:19], v6 offset:10752
    ds_read_b64_tr_b16 v[20:21], v6 offset:11264
    ds_read_b64_tr_b16 v[22:23], v6 offset:11776
    s_waitcnt lgkmcnt(0)
    v_mfma_f32_32x32x16_bf16 v[208:223], v[16:19], v[104:107], v[208:223]
    v_mfma_f32_32x32x16_bf16 v[208:223], v[20:23], v[108:111], v[208:223]
    s_nop 7
aa_pk_64:
    s_add_u32 s5, s37, 192
    s_cmp_lt_u32 s5, 256
    s_cbranch_scc1 aa_pk_65

    ds_read_b64_tr_b16 v[16:17], v6 offset:12288
    ds_read_b64_tr_b16 v[18:19], v6 offset:12800
    ds_read_b64_tr_b16 v[20:21], v6 offset:13312
    ds_read_b64_tr_b16 v[22:23], v6 offset:13824
    s_waitcnt lgkmcnt(0)
    v_mfma_f32_32x32x16_bf16 v[208:223], v[16:19], v[112:115], v[208:223]
    v_mfma_f32_32x32x16_bf16 v[208:223], v[20:23], v[116:119], v[208:223]
    s_nop 7
aa_pk_65:
    s_add_u32 s5, s37, 224
    s_cmp_lt_u32 s5, 256
    s_cbranch_scc1 aa_pk_66

    ds_read_b64_tr_b16 v[16:17], v6 offset:14336
    ds_read_b64_tr_b16 v[18:19], v6 offset:14848
    ds_read_b64_tr_b16 v[20:21], v6 offset:15360
    ds_read_b64_tr_b16 v[22:23], v6 offset:15872
    s_waitcnt lgkmcnt(0)
    v_mfma_f32_32x32x16_bf16 v[208:223], v[16:19], v[120:123], v[208:223]
    v_mfma_f32_32x32x16_bf16 v[208:223], v[20:23], v[124:127], v[208:223]
    s_nop 7
aa_pk_66:
    s_add_u32 s5, s37, 256
    s_cmp_lt_u32 s5, 256
    s_cbranch_scc1 aa_pk_67

    ds_read_b64_tr_b16 v[16:17], v6 offset:16384
    ds_read_b64_tr_b16 v[18:19], v6 offset:16896
    ds_read_b64_tr_b16 v[20:21], v6 offset:17408
    ds_read_b64_tr_b16 v[22:23], v6 offset:17920
    s_waitcnt lgkmcnt(0)
    v_mfma_f32_32x32x16_bf16 v[208:223], v[16:19], v[128:131], v[208:223]
    v_mfma_f32_32x32x16_bf16 v[208:223], v[20:23], v[132:135], v[208:223]
    s_nop 7
aa_pk_67:
    s_nop 15
    v_and_b32 v2, 31, v1
    v_add_u32 v2, s37, v2
    v_lshlrev_b32 v2, 11, v2
    v_lshrrev_b32 v4, 5, v1
    v_lshlrev_b32 v4, 3, v4
    v_add_u32 v2, v2, v4
    s_lshl_b32 s3, s36, 6
    v_add_u32 v2, s3, v2

    v_cvt_pk_bf16_f32 v16, v208, v209
    v_cvt_pk_bf16_f32 v17, v210, v211
    buffer_store_dwordx2 v[16:17], v2, s[12:15], 0 offen offset:0
    v_cvt_pk_bf16_f32 v18, v212, v213
    v_cvt_pk_bf16_f32 v19, v214, v215
    buffer_store_dwordx2 v[18:19], v2, s[12:15], 0 offen offset:16
    v_cvt_pk_bf16_f32 v20, v216, v217
    v_cvt_pk_bf16_f32 v21, v218, v219
    buffer_store_dwordx2 v[20:21], v2, s[12:15], 0 offen offset:32
    v_cvt_pk_bf16_f32 v22, v220, v221
    v_cvt_pk_bf16_f32 v23, v222, v223
    buffer_store_dwordx2 v[22:23], v2, s[12:15], 0 offen offset:48
aa_done_40:
    s_endpgm
.globl attnb_kernel
.p2align 8
.type attnb_kernel,@function
attnb_kernel:
    s_cmp_ge_u32 s2, 512
    s_cbranch_scc1 ab_done_68
    v_and_b32 v1, 63, v0
    v_lshrrev_b32 v2, 6, v0
    s_nop 0
    v_readfirstlane_b32 s38, v2
    s_nop 3
    s_lshl_b32 s3, s2, 2
    s_add_u32 s3, s3, s38
    s_lshr_b32 s37, s3, 5
    s_and_b32 s36, s3, 31

    s_load_dwordx2 s[8:9], s[0:1], 96
    s_waitcnt lgkmcnt(0)
    s_add_u32 s8, s8, 0xc00000
    s_addc_u32 s9, s9, 0
    s_mov_b32 s10, 0x1000000
    s_mov_b32 s11, 0x00020000
    s_load_dwordx2 s[12:13], s[0:1], 96
    s_waitcnt lgkmcnt(0)
    s_add_u32 s12, s12, 0x1c00000
    s_addc_u32 s13, s13, 0
    s_mov_b32 s14, 0x1000000
    s_mov_b32 s15, 0x00020000
    s_load_dwordx2 s[16:17], s[0:1], 96
    s_waitcnt lgkmcnt(0)
    s_add_u32 s16, s16, 0x2c00000
    s_addc_u32 s17, s17, 0
    s_mov_b32 s18, 0x1000000
    s_mov_b32 s19, 0x00020000
    s_load_dwordx2 s[20:21], s[0:1], 96
    s_waitcnt lgkmcnt(0)
    s_add_u32 s20, s20, 0x5000000
    s_addc_u32 s21, s21, 0
    s_mov_b32 s22, 0x400000
    s_mov_b32 s23, 0x00020000
    s_load_dwordx2 s[24:25], s[0:1], 96
    s_waitcnt lgkmcnt(0)
    s_add_u32 s24, s24, 0x5400000
    s_addc_u32 s25, s25, 0
    s_mov_b32 s26, 0x400000
    s_mov_b32 s27, 0x00020000
    s_load_dwordx2 s[28:29], s[0:1], 96
    s_waitcnt lgkmcnt(0)
    s_add_u32 s28, s28, 0x4000000
    s_addc_u32 s29, s29, 0
    s_mov_b32 s30, 0x1000000
    s_mov_b32 s31, 0x00020000
    v_and_b32 v2, 31, v1
    v_lshlrev_b32 v3, 13, v2
    v_lshrrev_b32 v4, 5, v1
    v_lshlrev_b32 v5, 4, v4
    v_add_u32 v3, v3, v5
    s_lshl_b32 s3, s36, 8
    v_add_u32 v3, s3, v3
    s_lshl_b32 s4, s37, 18
    s_lshl_b32 s5, s37, 16

    buffer_load_dwordx4 v[8:11], v3, s[8:11], s4 offen offset:0
    buffer_load_dwordx4 v[12:15], v3, s[8:11], s4 offen offset:32
    buffer_load_dwordx4 v[16:19], v3, s[8:11], s4 offen offset:64
    buffer_load_dwordx4 v[20:23], v3, s[8:11], s4 offen offset:96
    buffer_load_dwordx4 v[24:27], v3, s[8:11], s4 offen offset:128
    buffer_load_dwordx4 v[28:31], v3, s[8:11], s4 offen offset:160
    buffer_load_dwordx4 v[32:35], v3, s[8:11], s4 offen offset:192
    buffer_load_dwordx4 v[36:39], v3, s[8:11], s4 offen offset:224
    buffer_load_dwordx4 v[40:43], v3, s[20:23], s5 offen offset:0
    buffer_load_dwordx4 v[44:47], v3, s[20:23], s5 offen offset:32
    buffer_load_dwordx4 v[48:51], v3, s[20:23], s5 offen offset:64
    buffer_load_dwordx4 v[52:55], v3, s[20:23], s5 offen offset:96
    buffer_load_dwordx4 v[56:59], v3, s[20:23], s5 offen offset:128
    buffer_load_dwordx4 v[60:63], v3, s[20:23], s5 offen offset:160
    buffer_load_dwordx4 v[64:67], v3, s[20:23], s5 offen offset:192
    buffer_load_dwordx4 v[68:71], v3, s[20:23], s5 offen offset:224
    buffer_load_dwordx4 v[72:75], v3, s[12:15], s4 offen offset:0
    buffer_load_dwordx4 v[76:79], v3, s[12:15], s4 offen offset:32
    buffer_load_dwordx4 v[80:83], v3, s[12:15], s4 offen offset:64
    buffer_load_dwordx4 v[84:87], v3, s[12:15], s4 offen offset:96
    buffer_load_dwordx4 v[88:91], v3, s[12:15], s4 offen offset:128
    buffer_load_dwordx4 v[92:95], v3, s[12:15], s4 offen offset:160
    buffer_load_dwordx4 v[96:99], v3, s[12:15], s4 offen offset:192
    buffer_load_dwordx4 v[100:103], v3, s[12:15], s4 offen offset:224
    v_lshrrev_b32 v2, 4, v1
    v_lshlrev_b32 v6, 13, v2
    v_bfe_u32 v4, v1, 2, 2
    v_xor_b32 v4, v4, v2
    v_lshlrev_b32 v4, 6, v4
    v_add_u32 v6, v6, v4
    v_and_b32 v4, 3, v1
    v_lshlrev_b32 v4, 4, v4
    v_add_u32 v6, v6, v4
    v_add_u32 v6, s3, v6
    s_lshl_b32 s33, s38, 14
    s_mov_b32 s6, s5
    s_mov_b32 s7, s4

    s_add_u32 m0, s33, 0
    s_nop 0
    buffer_load_dwordx4 v6, s[24:27], s6 offen lds
    s_add_u32 s6, s6, 0x8000
    s_add_u32 m0, s33, 1024
    s_nop 0
    buffer_load_dwordx4 v6, s[24:27], s6 offen lds
    s_add_u32 s6, s6, 0x8000
    s_add_u32 m0, s33, 2048
    s_nop 0
    buffer_load_dwordx4 v6, s[24:27], s6 offen lds
    s_add_u32 s6, s6, 0x8000
    s_add_u32 m0, s33, 3072
    s_nop 0
    buffer_load_dwordx4 v6, s[24:27], s6 offen lds
    s_add_u32 s6, s6, 0x8000
    s_add_u32 m0, s33, 4096
    s_nop 0
    buffer_load_dwordx4 v6, s[24:27], s6 offen lds
    s_add_u32 s6, s6, 0x8000
    s_add_u32 m0, s33, 5120
    s_nop 0
    buffer_load_dwordx4 v6, s[24:27], s6 offen lds
    s_add_u32 s6, s6, 0x8000
    s_add_u32 m0, s33, 6144
    s_nop 0
    buffer_load_dwordx4 v6, s[24:27], s6 offen lds
    s_add_u32 s6, s6, 0x8000
    s_add_u32 m0, s33, 7168
    s_nop 0
    buffer_load_dwordx4 v6, s[24:27], s6 offen lds
    s_add_u32 s6, s6, 0x8000
    s_add_u32 m0, s33, 8192
    s_nop 0
    buffer_load_dwordx4 v6, s[16:19], s7 offen lds
    s_add_u32 s7, s7, 0x8000
    s_add_u32 m0, s33, 9216
    s_nop 0
    buffer_load_dwordx4 v6, s[16:19], s7 offen lds
    s_add_u32 s7, s7, 0x8000
    s_add_u32 m0, s33, 10240
    s_nop 0
    buffer_load_dwordx4 v6, s[16:19], s7 offen lds
    s_add_u32 s7, s7, 0x8000
    s_add_u32 m0, s33, 11264
    s_nop 0
    buffer_load_dwordx4 v6, s[16:19], s7 offen lds
    s_add_u32 s7, s7, 0x8000
    s_add_u32 m0, s33, 12288
    s_nop 0
    buffer_load_dwordx4 v6, s[16:19], s7 offen lds
    s_add_u32 s7, s7, 0x8000
    s_add_u32 m0, s33, 13312
    s_nop 0
    buffer_load_dwordx4 v6, s[16:19], s7 offen lds
    s_add_u32 s7, s7, 0x8000
    s_add_u32 m0, s33, 14336
    s_nop 0
    buffer_load_dwordx4 v6, s[16:19], s7 offen lds
    s_add_u32 s7, s7, 0x8000
    s_add_u32 m0, s33, 15360
    s_nop 0
    buffer_load_dwordx4 v6, s[16:19], s7 offen lds
    s_add_u32 s7, s7, 0x8000
    v_mov_b32 v104, 0
    v_mov_b32 v105, 0
    v_mov_b32 v106, 0
    v_mov_b32 v107, 0
    v_mov_b32 v108, 0
    v_mov_b32 v109, 0
    v_mov_b32 v110, 0
    v_mov_b32 v111, 0
    v_mov_b32 v112, 0
    v_mov_b32 v113, 0
    v_mov_b32 v114, 0
    v_mov_b32 v115, 0
    v_mov_b32 v116, 0
    v_mov_b32 v117, 0
    v_mov_b32 v118, 0
    v_mov_b32 v119, 0
    v_mov_b32 v120, 0
    v_mov_b32 v121, 0
    v_mov_b32 v122, 0
    v_mov_b32 v123, 0
    v_mov_b32 v124, 0
    v_mov_b32 v125, 0
    v_mov_b32 v126, 0
    v_mov_b32 v127, 0
    v_mov_b32 v128, 0
    v_mov_b32 v129, 0
    v_mov_b32 v130, 0
    v_mov_b32 v131, 0
    v_mov_b32 v132, 0
    v_mov_b32 v133, 0
    v_mov_b32 v134, 0
    v_mov_b32 v135, 0
    s_waitcnt vmcnt(16)
    v_mfma_f32_32x32x16_bf16 v[104:119], v[40:43], v[8:11], v[104:119]
    v_mfma_f32_32x32x16_bf16 v[104:119], v[44:47], v[12:15], v[104:119]
    v_mfma_f32_32x32x16_bf16 v[104:119], v[48:51], v[16:19], v[104:119]
    v_mfma_f32_32x32x16_bf16 v[104:119], v[52:55], v[20:23], v[104:119]
    v_mfma_f32_32x32x16_bf16 v[104:119], v[56:59], v[24:27], v[104:119]
    v_mfma_f32_32x32x16_bf16 v[104:119], v[60:63], v[28:31], v[104:119]
    v_mfma_f32_32x32x16_bf16 v[104:119], v[64:67], v[32:35], v[104:119]
    v_mfma_f32_32x32x16_bf16 v[104:119], v[68:71], v[36:39], v[104:119]
    v_mfma_f32_32x32x16_bf16 v[120:135], v[72:75], v[8:11], v[120:135]
    v_mfma_f32_32x32x16_bf16 v[120:135], v[76:79], v[12:15], v[120:135]
    v_mfma_f32_32x32x16_bf16 v[120:135], v[80:83], v[16:19], v[120:135]
    v_mfma_f32_32x32x16_bf16 v[120:135], v[84:87], v[20:23], v[120:135]
    v_mfma_f32_32x32x16_bf16 v[120:135], v[88:91], v[24:27], v[120:135]
    v_mfma_f32_32x32x16_bf16 v[120:135], v[92:95], v[28:31], v[120:135]
    v_mfma_f32_32x32x16_bf16 v[120:135], v[96:99], v[32:35], v[120:135]
    v_mfma_f32_32x32x16_bf16 v[120:135], v[100:103], v[36:39], v[120:135]
    s_nop 15
    s_mov_b32 s3, 0x3db504f3
    v_cvt_pk_bf16_f32 v104, v104, v104
    v_lshlrev_b32 v104, 16, v104
    v_mul_f32 v104, s3, v104
    v_cvt_pk_bf16_f32 v104, v104, v104
    v_lshlrev_b32 v104, 16, v104
    v_cvt_pk_bf16_f32 v105, v105, v105
    v_lshlrev_b32 v105, 16, v105
    v_mul_f32 v105, s3, v105
    v_cvt_pk_bf16_f32 v105, v105, v105
    v_lshlrev_b32 v105, 16, v105
    v_cvt_pk_bf16_f32 v106, v106, v106
    v_lshlrev_b32 v106, 16, v106
    v_mul_f32 v106, s3, v106
    v_cvt_pk_bf16_f32 v106, v106, v106
    v_lshlrev_b32 v106, 16, v106
    v_cvt_pk_bf16_f32 v107, v107, v107
    v_lshlrev_b32 v107, 16, v107
    v_mul_f32 v107, s3, v107
    v_cvt_pk_bf16_f32 v107, v107, v107
    v_lshlrev_b32 v107, 16, v107
    v_cvt_pk_bf16_f32 v108, v108, v108
    v_lshlrev_b32 v108, 16, v108
    v_mul_f32 v108, s3, v108
    v_cvt_pk_bf16_f32 v108, v108, v108
    v_lshlrev_b32 v108, 16, v108
    v_cvt_pk_bf16_f32 v109, v109, v109
    v_lshlrev_b32 v109, 16, v109
    v_mul_f32 v109, s3, v109
    v_cvt_pk_bf16_f32 v109, v109, v109
    v_lshlrev_b32 v109, 16, v109
    v_cvt_pk_bf16_f32 v110, v110, v110
    v_lshlrev_b32 v110, 16, v110
    v_mul_f32 v110, s3, v110
    v_cvt_pk_bf16_f32 v110, v110, v110
    v_lshlrev_b32 v110, 16, v110
    v_cvt_pk_bf16_f32 v111, v111, v111
    v_lshlrev_b32 v111, 16, v111
    v_mul_f32 v111, s3, v111
    v_cvt_pk_bf16_f32 v111, v111, v111
    v_lshlrev_b32 v111, 16, v111
    v_cvt_pk_bf16_f32 v112, v112, v112
    v_lshlrev_b32 v112, 16, v112
    v_mul_f32 v112, s3, v112
    v_cvt_pk_bf16_f32 v112, v112, v112
    v_lshlrev_b32 v112, 16, v112
    v_cvt_pk_bf16_f32 v113, v113, v113
    v_lshlrev_b32 v113, 16, v113
    v_mul_f32 v113, s3, v113
    v_cvt_pk_bf16_f32 v113, v113, v113
    v_lshlrev_b32 v113, 16, v113
    v_cvt_pk_bf16_f32 v114, v114, v114
    v_lshlrev_b32 v114, 16, v114
    v_mul_f32 v114, s3, v114
    v_cvt_pk_bf16_f32 v114, v114, v114
    v_lshlrev_b32 v114, 16, v114
    v_cvt_pk_bf16_f32 v115, v115, v115
    v_lshlrev_b32 v115, 16, v115
    v_mul_f32 v115, s3, v115
    v_cvt_pk_bf16_f32 v115, v115, v115
    v_lshlrev_b32 v115, 16, v115
    v_cvt_pk_bf16_f32 v116, v116, v116
    v_lshlrev_b32 v116, 16, v116
    v_mul_f32 v116, s3, v116
    v_cvt_pk_bf16_f32 v116, v116, v116
    v_lshlrev_b32 v116, 16, v116
    v_cvt_pk_bf16_f32 v117, v117, v117
    v_lshlrev_b32 v117, 16, v117
    v_mul_f32 v117, s3, v117
    v_cvt_pk_bf16_f32 v117, v117, v117
    v_lshlrev_b32 v117, 16, v117
    v_cvt_pk_bf16_f32 v118, v118, v118
    v_lshlrev_b32 v118, 16, v118
    v_mul_f32 v118, s3, v118
    v_cvt_pk_bf16_f32 v118, v118, v118
    v_lshlrev_b32 v118, 16, v118
    v_cvt_pk_bf16_f32 v119, v119, v119
    v_lshlrev_b32 v119, 16, v119
    v_mul_f32 v119, s3, v119
    v_cvt_pk_bf16_f32 v119, v119, v119
    v_lshlrev_b32 v119, 16, v119
    v_cvt_pk_bf16_f32 v120, v120, v120
    v_lshlrev_b32 v120, 16, v120
    v_mul_f32 v120, s3, v120
    v_cvt_pk_bf16_f32 v120, v120, v120
    v_lshlrev_b32 v120, 16, v120
    v_cvt_pk_bf16_f32 v121, v121, v121
    v_lshlrev_b32 v121, 16, v121
    v_mul_f32 v121, s3, v121
    v_cvt_pk_bf16_f32 v121, v121, v121
    v_lshlrev_b32 v121, 16, v121
    v_cvt_pk_bf16_f32 v122, v122, v122
    v_lshlrev_b32 v122, 16, v122
    v_mul_f32 v122, s3, v122
    v_cvt_pk_bf16_f32 v122, v122, v122
    v_lshlrev_b32 v122, 16, v122
    v_cvt_pk_bf16_f32 v123, v123, v123
    v_lshlrev_b32 v123, 16, v123
    v_mul_f32 v123, s3, v123
    v_cvt_pk_bf16_f32 v123, v123, v123
    v_lshlrev_b32 v123, 16, v123
    v_cvt_pk_bf16_f32 v124, v124, v124
    v_lshlrev_b32 v124, 16, v124
    v_mul_f32 v124, s3, v124
    v_cvt_pk_bf16_f32 v124, v124, v124
    v_lshlrev_b32 v124, 16, v124
    v_cvt_pk_bf16_f32 v125, v125, v125
    v_lshlrev_b32 v125, 16, v125
    v_mul_f32 v125, s3, v125
    v_cvt_pk_bf16_f32 v125, v125, v125
    v_lshlrev_b32 v125, 16, v125
    v_cvt_pk_bf16_f32 v126, v126, v126
    v_lshlrev_b32 v126, 16, v126
    v_mul_f32 v126, s3, v126
    v_cvt_pk_bf16_f32 v126, v126, v126
    v_lshlrev_b32 v126, 16, v126
    v_cvt_pk_bf16_f32 v127, v127, v127
    v_lshlrev_b32 v127, 16, v127
    v_mul_f32 v127, s3, v127
    v_cvt_pk_bf16_f32 v127, v127, v127
    v_lshlrev_b32 v127, 16, v127
    v_cvt_pk_bf16_f32 v128, v128, v128
    v_lshlrev_b32 v128, 16, v128
    v_mul_f32 v128, s3, v128
    v_cvt_pk_bf16_f32 v128, v128, v128
    v_lshlrev_b32 v128, 16, v128
    v_cvt_pk_bf16_f32 v129, v129, v129
    v_lshlrev_b32 v129, 16, v129
    v_mul_f32 v129, s3, v129
    v_cvt_pk_bf16_f32 v129, v129, v129
    v_lshlrev_b32 v129, 16, v129
    v_cvt_pk_bf16_f32 v130, v130, v130
    v_lshlrev_b32 v130, 16, v130
    v_mul_f32 v130, s3, v130
    v_cvt_pk_bf16_f32 v130, v130, v130
    v_lshlrev_b32 v130, 16, v130
    v_cvt_pk_bf16_f32 v131, v131, v131
    v_lshlrev_b32 v131, 16, v131
    v_mul_f32 v131, s3, v131
    v_cvt_pk_bf16_f32 v131, v131, v131
    v_lshlrev_b32 v131, 16, v131
    v_cvt_pk_bf16_f32 v132, v132, v132
    v_lshlrev_b32 v132, 16, v132
    v_mul_f32 v132, s3, v132
    v_cvt_pk_bf16_f32 v132, v132, v132
    v_lshlrev_b32 v132, 16, v132
    v_cvt_pk_bf16_f32 v133, v133, v133
    v_lshlrev_b32 v133, 16, v133
    v_mul_f32 v133, s3, v133
    v_cvt_pk_bf16_f32 v133, v133, v133
    v_lshlrev_b32 v133, 16, v133
    v_cvt_pk_bf16_f32 v134, v134, v134
    v_lshlrev_b32 v134, 16, v134
    v_mul_f32 v134, s3, v134
    v_cvt_pk_bf16_f32 v134, v134, v134
    v_lshlrev_b32 v134, 16, v134
    v_cvt_pk_bf16_f32 v135, v135, v135
    v_lshlrev_b32 v135, 16, v135
    v_mul_f32 v135, s3, v135
    v_cvt_pk_bf16_f32 v135, v135, v135
    v_lshlrev_b32 v135, 16, v135
    v_and_b32 v2, 31, v1
    v_lshrrev_b32 v4, 5, v1
    v_lshlrev_b32 v4, 2, v4
    v_sub_u32 v2, v2, v4
    v_mov_b32 v5, 0xff800000

    v_mov_b32 v108, v5
    v_mov_b32 v109, v5
    v_mov_b32 v110, v5
    v_mov_b32 v111, v5
    v_mov_b32 v112, v5
    v_mov_b32 v113, v5
    v_mov_b32 v114, v5
    v_mov_b32 v115, v5
    v_mov_b32 v116, v5
    v_mov_b32 v117, v5
    v_mov_b32 v118, v5
    v_mov_b32 v119, v5
    v_cmp_le_i32 vcc, 0, v2
    v_cndmask_b32 v120, v5, v120, vcc
    v_cmp_le_i32 vcc, 1, v2
    v_cndmask_b32 v121, v5, v121, vcc
    v_cmp_le_i32 vcc, 2, v2
    v_cndmask_b32 v122, v5, v122, vcc
    v_cmp_le_i32 vcc, 3, v2
    v_cndmask_b32 v123, v5, v123, vcc
    v_cmp_le_i32 vcc, 8, v2
    v_cndmask_b32 v124, v5, v124, vcc
    v_cmp_le_i32 vcc, 9, v2
    v_cndmask_b32 v125, v5, v125, vcc
    v_cmp_le_i32 vcc, 10, v2
    v_cndmask_b32 v126, v5, v126, vcc
    v_cmp_le_i32 vcc, 11, v2
    v_cndmask_b32 v127, v5, v127, vcc
    v_cmp_le_i32 vcc, 16, v2
    v_cndmask_b32 v128, v5, v128, vcc
    v_cmp_le_i32 vcc, 17, v2
    v_cndmask_b32 v129, v5, v129, vcc
    v_cmp_le_i32 vcc, 18, v2
    v_cndmask_b32 v130, v5, v130, vcc
    v_cmp_le_i32 vcc, 19, v2
    v_cndmask_b32 v131, v5, v131, vcc
    v_cmp_le_i32 vcc, 24, v2
    v_cndmask_b32 v132, v5, v132, vcc
    v_cmp_le_i32 vcc, 25, v2
    v_cndmask_b32 v133, v5, v133, vcc
    v_cmp_le_i32 vcc, 26, v2
    v_cndmask_b32 v134, v5, v134, vcc
    v_cmp_le_i32 vcc, 27, v2
    v_cndmask_b32 v135, v5, v135, vcc
    v_max_f32 v7, v104, v105
    v_max3_f32 v7, v7, v106, v107
    v_max3_f32 v7, v7, v108, v109
    v_max3_f32 v7, v7, v110, v111
    v_max3_f32 v7, v7, v112, v113
    v_max3_f32 v7, v7, v114, v115
    v_max3_f32 v7, v7, v116, v117
    v_max3_f32 v7, v7, v118, v119
    v_max3_f32 v7, v7, v120, v121
    v_max3_f32 v7, v7, v122, v123
    v_max3_f32 v7, v7, v124, v125
    v_max3_f32 v7, v7, v126, v127
    v_max3_f32 v7, v7, v128, v129
    v_max3_f32 v7, v7, v130, v131
    v_max3_f32 v7, v7, v132, v133
    v_max3_f32 v7, v7, v134, v135
    v_xor_b32 v2, 32, v1
    v_lshlrev_b32 v2, 2, v2
    ds_bpermute_b32 v4, v2, v7
    s_waitcnt lgkmcnt(0)
    v_max_f32 v7, v7, v4
    s_mov_b32 s3, 0x3fb8aa3b
    v_mul_f32 v7, s3, v7
    v_mov_b32 v5, 0

    v_fma_f32 v104, v104, s3, -v7
    v_exp_f32 v104, v104
    s_nop 0
    v_add_f32 v5, v5, v104
    v_fma_f32 v105, v105, s3, -v7
    v_exp_f32 v105, v105
    s_nop 0
    v_add_f32 v5, v5, v105
    v_fma_f32 v106, v106, s3, -v7
    v_exp_f32 v106, v106
    s_nop 0
    v_add_f32 v5, v5, v106
    v_fma_f32 v107, v107, s3, -v7
    v_exp_f32 v107, v107
    s_nop 0
    v_add_f32 v5, v5, v107
    v_fma_f32 v108, v108, s3, -v7
    v_exp_f32 v108, v108
    s_nop 0
    v_add_f32 v5, v5, v108
    v_fma_f32 v109, v109, s3, -v7
    v_exp_f32 v109, v109
    s_nop 0
    v_add_f32 v5, v5, v109
    v_fma_f32 v110, v110, s3, -v7
    v_exp_f32 v110, v110
    s_nop 0
    v_add_f32 v5, v5, v110
    v_fma_f32 v111, v111, s3, -v7
    v_exp_f32 v111, v111
    s_nop 0
    v_add_f32 v5, v5, v111
    v_fma_f32 v112, v112, s3, -v7
    v_exp_f32 v112, v112
    s_nop 0
    v_add_f32 v5, v5, v112
    v_fma_f32 v113, v113, s3, -v7
    v_exp_f32 v113, v113
    s_nop 0
    v_add_f32 v5, v5, v113
    v_fma_f32 v114, v114, s3, -v7
    v_exp_f32 v114, v114
    s_nop 0
    v_add_f32 v5, v5, v114
    v_fma_f32 v115, v115, s3, -v7
    v_exp_f32 v115, v115
    s_nop 0
    v_add_f32 v5, v5, v115
    v_fma_f32 v116, v116, s3, -v7
    v_exp_f32 v116, v116
    s_nop 0
    v_add_f32 v5, v5, v116
    v_fma_f32 v117, v117, s3, -v7
    v_exp_f32 v117, v117
    s_nop 0
    v_add_f32 v5, v5, v117
    v_fma_f32 v118, v118, s3, -v7
    v_exp_f32 v118, v118
    s_nop 0
    v_add_f32 v5, v5, v118
    v_fma_f32 v119, v119, s3, -v7
    v_exp_f32 v119, v119
    s_nop 0
    v_add_f32 v5, v5, v119
    v_fma_f32 v120, v120, s3, -v7
    v_exp_f32 v120, v120
    s_nop 0
    v_add_f32 v5, v5, v120
    v_fma_f32 v121, v121, s3, -v7
    v_exp_f32 v121, v121
    s_nop 0
    v_add_f32 v5, v5, v121
    v_fma_f32 v122, v122, s3, -v7
    v_exp_f32 v122, v122
    s_nop 0
    v_add_f32 v5, v5, v122
    v_fma_f32 v123, v123, s3, -v7
    v_exp_f32 v123, v123
    s_nop 0
    v_add_f32 v5, v5, v123
    v_fma_f32 v124, v124, s3, -v7
    v_exp_f32 v124, v124
    s_nop 0
    v_add_f32 v5, v5, v124
    v_fma_f32 v125, v125, s3, -v7
    v_exp_f32 v125, v125
    s_nop 0
    v_add_f32 v5, v5, v125
    v_fma_f32 v126, v126, s3, -v7
    v_exp_f32 v126, v126
    s_nop 0
    v_add_f32 v5, v5, v126
    v_fma_f32 v127, v127, s3, -v7
    v_exp_f32 v127, v127
    s_nop 0
    v_add_f32 v5, v5, v127
    v_fma_f32 v128, v128, s3, -v7
    v_exp_f32 v128, v128
    s_nop 0
    v_add_f32 v5, v5, v128
    v_fma_f32 v129, v129, s3, -v7
    v_exp_f32 v129, v129
    s_nop 0
    v_add_f32 v5, v5, v129
    v_fma_f32 v130, v130, s3, -v7
    v_exp_f32 v130, v130
    s_nop 0
    v_add_f32 v5, v5, v130
    v_fma_f32 v131, v131, s3, -v7
    v_exp_f32 v131, v131
    s_nop 0
    v_add_f32 v5, v5, v131
    v_fma_f32 v132, v132, s3, -v7
    v_exp_f32 v132, v132
    s_nop 0
    v_add_f32 v5, v5, v132
    v_fma_f32 v133, v133, s3, -v7
    v_exp_f32 v133, v133
    s_nop 0
    v_add_f32 v5, v5, v133
    v_fma_f32 v134, v134, s3, -v7
    v_exp_f32 v134, v134
    s_nop 0
    v_add_f32 v5, v5, v134
    v_fma_f32 v135, v135, s3, -v7
    v_exp_f32 v135, v135
    s_nop 0
    v_add_f32 v5, v5, v135
    ds_bpermute_b32 v4, v2, v5
    s_waitcnt lgkmcnt(0)
    v_add_f32 v5, v5, v4
    v_rcp_f32 v5, v5
    s_nop 0

    v_mul_f32 v104, v104, v5
    v_mul_f32 v105, v105, v5
    v_cvt_pk_bf16_f32 v8, v104, v105
    v_mul_f32 v106, v106, v5
    v_mul_f32 v107, v107, v5
    v_cvt_pk_bf16_f32 v9, v106, v107
    v_mul_f32 v108, v108, v5
    v_mul_f32 v109, v109, v5
    v_cvt_pk_bf16_f32 v10, v108, v109
    v_mul_f32 v110, v110, v5
    v_mul_f32 v111, v111, v5
    v_cvt_pk_bf16_f32 v11, v110, v111
    v_mul_f32 v112, v112, v5
    v_mul_f32 v113, v113, v5
    v_cvt_pk_bf16_f32 v12, v112, v113
    v_mul_f32 v114, v114, v5
    v_mul_f32 v115, v115, v5
    v_cvt_pk_bf16_f32 v13, v114, v115
    v_mul_f32 v116, v116, v5
    v_mul_f32 v117, v117, v5
    v_cvt_pk_bf16_f32 v14, v116, v117
    v_mul_f32 v118, v118, v5
    v_mul_f32 v119, v119, v5
    v_cvt_pk_bf16_f32 v15, v118, v119
    v_mul_f32 v120, v120, v5
    v_mul_f32 v121, v121, v5
    v_cvt_pk_bf16_f32 v16, v120, v121
    v_mul_f32 v122, v122, v5
    v_mul_f32 v123, v123, v5
    v_cvt_pk_bf16_f32 v17, v122, v123
    v_mul_f32 v124, v124, v5
    v_mul_f32 v125, v125, v5
    v_cvt_pk_bf16_f32 v18, v124, v125
    v_mul_f32 v126, v126, v5
    v_mul_f32 v127, v127, v5
    v_cvt_pk_bf16_f32 v19, v126, v127
    v_mul_f32 v128, v128, v5
    v_mul_f32 v129, v129, v5
    v_cvt_pk_bf16_f32 v20, v128, v129
    v_mul_f32 v130, v130, v5
    v_mul_f32 v131, v131, v5
    v_cvt_pk_bf16_f32 v21, v130, v131
    v_mul_f32 v132, v132, v5
    v_mul_f32 v133, v133, v5
    v_cvt_pk_bf16_f32 v22, v132, v133
    v_mul_f32 v134, v134, v5
    v_mul_f32 v135, v135, v5
    v_cvt_pk_bf16_f32 v23, v134, v135
    v_lshrrev_b32 v2, 5, v1
    v_lshlrev_b32 v2, 2, v2
    v_bfe_u32 v4, v1, 2, 2
    v_add_u32 v2, v2, v4
    v_lshlrev_b32 v6, 8, v2
    v_bfe_u32 v2, v1, 4, 1
    v_lshlrev_b32 v2, 5, v2
    v_add_u32 v6, v6, v2
    v_and_b32 v2, 3, v1
    v_lshlrev_b32 v2, 3, v2
    v_add_u32 v6, v6, v2
    v_add_u32 v6, s33, v6

    v_xor_b32 v2, 0, v4
    v_lshlrev_b32 v2, 6, v2
    v_add_u32 v24, v6, v2
    v_xor_b32 v2, 1, v4
    v_lshlrev_b32 v2, 6, v2
    v_add_u32 v25, v6, v2
    v_xor_b32 v2, 2, v4
    v_lshlrev_b32 v2, 6, v2
    v_add_u32 v26, v6, v2
    v_xor_b32 v2, 3, v4
    v_lshlrev_b32 v2, 6, v2
    v_add_u32 v27, v6, v2
    v_mov_b32 v40, 0
    v_mov_b32 v41, 0
    v_mov_b32 v42, 0
    v_mov_b32 v43, 0
    v_mov_b32 v44, 0
    v_mov_b32 v45, 0
    v_mov_b32 v46, 0
    v_mov_b32 v47, 0
    v_mov_b32 v48, 0
    v_mov_b32 v49, 0
    v_mov_b32 v50, 0
    v_mov_b32 v51, 0
    v_mov_b32 v52, 0
    v_mov_b32 v53, 0
    v_mov_b32 v54, 0
    v_mov_b32 v55, 0
    v_mov_b32 v56, 0
    v_mov_b32 v57, 0
    v_mov_b32 v58, 0
    v_mov_b32 v59, 0
    v_mov_b32 v60, 0
    v_mov_b32 v61, 0
    v_mov_b32 v62, 0
    v_mov_b32 v63, 0
    v_mov_b32 v64, 0
    v_mov_b32 v65, 0
    v_mov_b32 v66, 0
    v_mov_b32 v67, 0
    v_mov_b32 v68, 0
    v_mov_b32 v69, 0
    v_mov_b32 v70, 0
    v_mov_b32 v71, 0
    v_mov_b32 v72, 0
    v_mov_b32 v73, 0
    v_mov_b32 v74, 0
    v_mov_b32 v75, 0
    v_mov_b32 v76, 0
    v_mov_b32 v77, 0
    v_mov_b32 v78, 0
    v_mov_b32 v79, 0
    v_mov_b32 v80, 0
    v_mov_b32 v81, 0
    v_mov_b32 v82, 0
    v_mov_b32 v83, 0
    v_mov_b32 v84, 0
    v_mov_b32 v85, 0
    v_mov_b32 v86, 0
    v_mov_b32 v87, 0
    v_mov_b32 v88, 0
    v_mov_b32 v89, 0
    v_mov_b32 v90, 0
    v_mov_b32 v91, 0
    v_mov_b32 v92, 0
    v_mov_b32 v93, 0
    v_mov_b32 v94, 0
    v_mov_b32 v95, 0
    v_mov_b32 v96, 0
    v_mov_b32 v97, 0
    v_mov_b32 v98, 0
    v_mov_b32 v99, 0
    v_mov_b32 v100, 0
    v_mov_b32 v101, 0
    v_mov_b32 v102, 0
    v_mov_b32 v103, 0
    s_waitcnt vmcnt(0)
    ds_read_b64_tr_b16 v[28:29], v24 offset:0
    ds_read_b64_tr_b16 v[30:31], v24 offset:2048
    ds_read_b64_tr_b16 v[32:33], v24 offset:8192
    ds_read_b64_tr_b16 v[34:35], v24 offset:10240
    ds_read_b64_tr_b16 v[36:37], v24 offset:12288
    ds_read_b64_tr_b16 v[38:39], v24 offset:14336
    s_waitcnt lgkmcnt(0)
    v_mfma_f32_32x32x16_bf16 v[40:55], v[28:31], v[8:11], v[40:55]
    v_mfma_f32_32x32x16_bf16 v[40:55], v[32:35], v[16:19], v[40:55]
    v_mfma_f32_32x32x16_bf16 v[40:55], v[36:39], v[20:23], v[40:55]
    s_nop 7
    ds_read_b64_tr_b16 v[28:29], v25 offset:0
    ds_read_b64_tr_b16 v[30:31], v25 offset:2048
    ds_read_b64_tr_b16 v[32:33], v25 offset:8192
    ds_read_b64_tr_b16 v[34:35], v25 offset:10240
    ds_read_b64_tr_b16 v[36:37], v25 offset:12288
    ds_read_b64_tr_b16 v[38:39], v25 offset:14336
    s_waitcnt lgkmcnt(0)
    v_mfma_f32_32x32x16_bf16 v[56:71], v[28:31], v[8:11], v[56:71]
    v_mfma_f32_32x32x16_bf16 v[56:71], v[32:35], v[16:19], v[56:71]
    v_mfma_f32_32x32x16_bf16 v[56:71], v[36:39], v[20:23], v[56:71]
    s_nop 7
    ds_read_b64_tr_b16 v[28:29], v26 offset:0
    ds_read_b64_tr_b16 v[30:31], v26 offset:2048
    ds_read_b64_tr_b16 v[32:33], v26 offset:8192
    ds_read_b64_tr_b16 v[34:35], v26 offset:10240
    ds_read_b64_tr_b16 v[36:37], v26 offset:12288
    ds_read_b64_tr_b16 v[38:39], v26 offset:14336
    s_waitcnt lgkmcnt(0)
    v_mfma_f32_32x32x16_bf16 v[72:87], v[28:31], v[8:11], v[72:87]
    v_mfma_f32_32x32x16_bf16 v[72:87], v[32:35], v[16:19], v[72:87]
    v_mfma_f32_32x32x16_bf16 v[72:87], v[36:39], v[20:23], v[72:87]
    s_nop 7
    ds_read_b64_tr_b16 v[28:29], v27 offset:0
    ds_read_b64_tr_b16 v[30:31], v27 offset:2048
    ds_read_b64_tr_b16 v[32:33], v27 offset:8192
    ds_read_b64_tr_b16 v[34:35], v27 offset:10240
    ds_read_b64_tr_b16 v[36:37], v27 offset:12288
    ds_read_b64_tr_b16 v[38:39], v27 offset:14336
    s_waitcnt lgkmcnt(0)
    v_mfma_f32_32x32x16_bf16 v[88:103], v[28:31], v[8:11], v[88:103]
    v_mfma_f32_32x32x16_bf16 v[88:103], v[32:35], v[16:19], v[88:103]
    v_mfma_f32_32x32x16_bf16 v[88:103], v[36:39], v[20:23], v[88:103]
    s_nop 7
    s_nop 15
    v_and_b32 v2, 31, v1
    v_lshlrev_b32 v2, 13, v2
    v_lshrrev_b32 v4, 5, v1
    v_lshlrev_b32 v4, 3, v4
    v_add_u32 v2, v2, v4
    s_lshl_b32 s3, s36, 8
    v_add_u32 v2, s3, v2

    v_cvt_pk_bf16_f32 v8, v40, v41
    v_cvt_pk_bf16_f32 v9, v42, v43
    buffer_store_dwordx2 v[8:9], v2, s[28:31], s4 offen offset:0
    v_cvt_pk_bf16_f32 v10, v44, v45
    v_cvt_pk_bf16_f32 v11, v46, v47
    buffer_store_dwordx2 v[10:11], v2, s[28:31], s4 offen offset:16
    v_cvt_pk_bf16_f32 v12, v48, v49
    v_cvt_pk_bf16_f32 v13, v50, v51
    buffer_store_dwordx2 v[12:13], v2, s[28:31], s4 offen offset:32
    v_cvt_pk_bf16_f32 v14, v52, v53
    v_cvt_pk_bf16_f32 v15, v54, v55
    buffer_store_dwordx2 v[14:15], v2, s[28:31], s4 offen offset:48
    v_cvt_pk_bf16_f32 v8, v56, v57
    v_cvt_pk_bf16_f32 v9, v58, v59
    buffer_store_dwordx2 v[8:9], v2, s[28:31], s4 offen offset:64
    v_cvt_pk_bf16_f32 v10, v60, v61
    v_cvt_pk_bf16_f32 v11, v62, v63
    buffer_store_dwordx2 v[10:11], v2, s[28:31], s4 offen offset:80
    v_cvt_pk_bf16_f32 v12, v64, v65
    v_cvt_pk_bf16_f32 v13, v66, v67
    buffer_store_dwordx2 v[12:13], v2, s[28:31], s4 offen offset:96
    v_cvt_pk_bf16_f32 v14, v68, v69
    v_cvt_pk_bf16_f32 v15, v70, v71
    buffer_store_dwordx2 v[14:15], v2, s[28:31], s4 offen offset:112
    v_cvt_pk_bf16_f32 v8, v72, v73
    v_cvt_pk_bf16_f32 v9, v74, v75
    buffer_store_dwordx2 v[8:9], v2, s[28:31], s4 offen offset:128
    v_cvt_pk_bf16_f32 v10, v76, v77
    v_cvt_pk_bf16_f32 v11, v78, v79
    buffer_store_dwordx2 v[10:11], v2, s[28:31], s4 offen offset:144
    v_cvt_pk_bf16_f32 v12, v80, v81
    v_cvt_pk_bf16_f32 v13, v82, v83
    buffer_store_dwordx2 v[12:13], v2, s[28:31], s4 offen offset:160
    v_cvt_pk_bf16_f32 v14, v84, v85
    v_cvt_pk_bf16_f32 v15, v86, v87
    buffer_store_dwordx2 v[14:15], v2, s[28:31], s4 offen offset:176
    v_cvt_pk_bf16_f32 v8, v88, v89
    v_cvt_pk_bf16_f32 v9, v90, v91
    buffer_store_dwordx2 v[8:9], v2, s[28:31], s4 offen offset:192
    v_cvt_pk_bf16_f32 v10, v92, v93
    v_cvt_pk_bf16_f32 v11, v94, v95
    buffer_store_dwordx2 v[10:11], v2, s[28:31], s4 offen offset:208
    v_cvt_pk_bf16_f32 v12, v96, v97
    v_cvt_pk_bf16_f32 v13, v98, v99
    buffer_store_dwordx2 v[12:13], v2, s[28:31], s4 offen offset:224
    v_cvt_pk_bf16_f32 v14, v100, v101
    v_cvt_pk_bf16_f32 v15, v102, v103
    buffer_store_dwordx2 v[14:15], v2, s[28:31], s4 offen offset:240
ab_done_68:
    s_endpgm
.section .rodata,"a"
.p2align 6
.amdhsa_kernel gemm1_kernel
  .amdhsa_next_free_vgpr 128
  .amdhsa_next_free_sgpr 102
  .amdhsa_accum_offset 128
  .amdhsa_group_segment_fixed_size 0
  .amdhsa_kernarg_size 104
  .amdhsa_user_sgpr_count 2
  .amdhsa_user_sgpr_kernarg_segment_ptr 1
  .amdhsa_system_sgpr_workgroup_id_x 1
.end_amdhsa_kernel
.p2align 6
.amdhsa_kernel gemm2_kernel
  .amdhsa_next_free_vgpr 128
  .amdhsa_next_free_sgpr 102
  .amdhsa_accum_offset 128
  .amdhsa_group_segment_fixed_size 0
  .amdhsa_kernarg_size 104
  .amdhsa_user_sgpr_count 2
  .amdhsa_user_sgpr_kernarg_segment_ptr 1
  .amdhsa_system_sgpr_workgroup_id_x 1
.end_amdhsa_kernel
.p2align 6
.amdhsa_kernel init_kernel
  .amdhsa_next_free_vgpr 8
  .amdhsa_next_free_sgpr 102
  .amdhsa_accum_offset 8
  .amdhsa_group_segment_fixed_size 0
  .amdhsa_kernarg_size 104
  .amdhsa_user_sgpr_count 2
  .amdhsa_user_sgpr_kernarg_segment_ptr 1
  .amdhsa_system_sgpr_workgroup_id_x 1
.end_amdhsa_kernel
.p2align 6
.amdhsa_kernel mega_kernel
  .amdhsa_next_free_vgpr 256
  .amdhsa_next_free_sgpr 102
  .amdhsa_accum_offset 256
  .amdhsa_group_segment_fixed_size 0
  .amdhsa_kernarg_size 104
  .amdhsa_user_sgpr_count 2
  .amdhsa_user_sgpr_kernarg_segment_ptr 1
  .amdhsa_system_sgpr_workgroup_id_x 1
.end_amdhsa_kernel
.p2align 6
.amdhsa_kernel attnb_kernel
  .amdhsa_next_free_vgpr 136
  .amdhsa_next_free_sgpr 102
  .amdhsa_accum_offset 136
  .amdhsa_group_segment_fixed_size 0
  .amdhsa_kernarg_size 104
  .amdhsa_user_sgpr_count 2
  .amdhsa_user_sgpr_kernarg_segment_ptr 1
  .amdhsa_system_sgpr_workgroup_id_x 1
.end_amdhsa_kernel
.p2align 6
.amdhsa_kernel attna_kernel
  .amdhsa_next_free_vgpr 224
  .amdhsa_next_free_sgpr 102
  .amdhsa_accum_offset 224
  .amdhsa_group_segment_fixed_size 0
  .amdhsa_kernarg_size 104
  .amdhsa_user_sgpr_count 2
  .amdhsa_user_sgpr_kernarg_segment_ptr 1
  .amdhsa_system_sgpr_workgroup_id_x 1
.end_amdhsa_kernel
```
